```python
import torch

def _softmax(x, axis=-1):
    return torch.softmax(x, dim=axis)
def _gelu(x):
    return torch.nn.functional.gelu(x, approximate="tanh")
def _silu(x):
    return torch.nn.functional.silu(x)
def _sigmoid(x):
    return torch.sigmoid(x)
def _layernorm(x, axis=-1, eps=1e-5):
    m = x.mean(dim=axis, keepdim=True)
    v = x.var(dim=axis, keepdim=True, unbiased=False)
    return (x - m) / torch.sqrt(v + eps)
def _scatter_add(tgt, idx, src, axis=0):
    return tgt.clone().index_add_(axis, idx, src)
def _segment_sum(src, seg, n):
    out = torch.zeros((n,) + src.shape[1:], dtype=src.dtype)
    return out.index_add_(0, seg, src)
def _pad(x, pw):
    flat = tuple(v for pair in reversed(pw) for v in pair)
    return torch.nn.functional.pad(x, flat)

kernel_name = 'standalone__paged_block_table_kv_radixattention__sampling'

def setup_inputs():

    _w = (lambda a: (lambda t: t.to(torch.bfloat16) if t.is_floating_point() else t)(torch.as_tensor(a)))
    B, H, Hkv, Dh = 8, 16, 8, 256
    Lk = 2048
    bs = 16
    nb = max(2, Lk // bs)
    P = max(1, nb // 2)
    n_phys = P + B * (nb - P)
    shared = torch.arange(P, dtype=torch.int64)
    priv = P + torch.arange(B * (nb - P), dtype=torch.int64).reshape(B, nb - P)
    bt = torch.cat([torch.tile(shared[None, :], (B, 1)), priv], dim=1)
    ctx = nb * bs - (torch.arange(1, B + 1, dtype=torch.int64) * 2654435761) % max(1, (nb * bs - P * bs) // 2)
    return {
        "q": _w((lambda *s: torch.randn(*s, dtype=torch.bfloat16) * 0.8)(B, H, Dh)),
        "k_cache": _w((lambda *s: torch.randn(*s, dtype=torch.bfloat16) * 0.8)(n_phys, bs, Hkv, Dh)),
        "v_cache": _w((lambda *s: torch.randn(*s, dtype=torch.bfloat16) * 0.05)(n_phys, bs, Hkv, Dh)),
        "block_table": _w(bt.to(torch.int64)),
        "ctx_lens": _w(torch.as_tensor(ctx).to(torch.int64)),
    }

def reference(q, k_cache, v_cache, block_table, ctx_lens):
    B, H, Dh = q.shape
    n_phys, bs, Hkv, _ = k_cache.shape
    nb = block_table.shape[1]
    Lk = nb * bs
    rep = H // Hkv
    k = k_cache[block_table].reshape(B, Lk, Hkv, Dh)
    v = v_cache[block_table].reshape(B, Lk, Hkv, Dh)
    k = (lambda x, n, axis: torch.repeat_interleave(x, n, dim=axis))(k, rep, axis=2)
    v = (lambda x, n, axis: torch.repeat_interleave(x, n, dim=axis))(v, rep, axis=2)
    scores = torch.einsum("bhd,bkhd->bhk", q, k) * (Dh ** -0.5)
    pos = torch.arange(Lk)
    valid = pos[None, :] < ctx_lens[:, None]
    scores = torch.where(valid[:, None, :], scores, -1e9)
    p = _softmax(scores, axis=-1)
    return torch.einsum("bhk,bkhd->bhd", p, v)
```

```asm
; @launch grid=(256,1,1) block=(512,1,1) lds=142848
.amdgcn_target "amdgcn-amd-amdhsa--gfx950"
.text
.p2align 12
.globl standalone__paged_block_table_kv_radixattention__sampling_kernel
.p2align 8
.type standalone__paged_block_table_kv_radixattention__sampling_kernel,@function
standalone__paged_block_table_kv_radixattention__sampling_kernel:
    s_load_dwordx4 s[12:15], s[0:1], 0
    s_cmp_ge_u32 s2, 0x100
    s_cbranch_scc1 L_end
    v_readfirstlane_b32 s3, v0
    s_getpc_b64 s[38:39]
L_pc:
    s_and_b32 s71, s2, 0xf8
    s_lshr_b32 s59, s3, 4
    s_lshl1_add_u32 s70, s71, s59
    s_add_u32 s70, s70, first_table-L_pc
    s_cmp_ge_u32 s3, 0x100
    s_cbranch_scc1 L_norow
    s_load_dword s42, s[38:39], s70
L_norow:
    s_lshr_b32 s59, s3, 3
    s_lshl3_add_u32 s71, s71, s59
    s_add_u32 s71, s71, plan_table-L_pc
    s_and_b32 s44, s2, 7
    v_and_b32 v1, 63, v0
    v_and_b32 v2, 15, v0
    v_bfe_u32 v3, v0, 4, 2
    v_bfe_u32 v24, v0, 1, 3
    v_and_b32 v25, 1, v0
    v_lshlrev_b32 v4, 12, v24
    v_lshl_or_b32 v26, v3, 1, v25
    v_lshl_or_b32 v4, v26, 4, v4
    v_add_u32 v5, 0x8000, v4
    s_mov_b32 s6, 37748736
    s_mov_b32 s7, 0x20000
    s_mov_b32 s10, 37748736
    s_mov_b32 s11, 0x20000
    s_lshl_b32 s60, s44, 9
    s_lshr_b32 s3, s3, 6
    s_lshl_b32 s63, s44, 10
    s_mov_b32 s18, 0x1000
    s_mov_b32 s19, 0x20000
    v_lshrrev_b32 v27, 5, v1
    v_xor_b32 v16, v27, v1
    v_lshlrev_b32 v16, 4, v16
    v_bfrev_b32 v27, 1
    v_add_u32 v28, 8, v24
    v_lshlrev_b32 v6, 13, v3
    v_lshl_or_b32 v6, v2, 4, v6
    v_lshlrev_b32 v25, 3, v1
    s_cmp_lt_u32 s3, 4
    s_cbranch_scc1 L_go
    s_branch L_wait
.p2align 4
.type first_table,@object
first_table:
.long 0x1c000020, 0x18017120, 0x1802d220, 0x18043320
.long 0x1c0cd020, 0x180e4120, 0x180fa220, 0x18110320
.long 0x1819a020, 0x181b0120, 0x181c6220, 0x181dc320
.long 0x1c266020, 0x1827d120, 0x18293220, 0x182a9320
.long 0x1c333020, 0x1834a120, 0x18360220, 0x18376320
.long 0x26000717, 0x22019f17, 0x22031f17, 0x22049f17
.long 0x220d5707, 0x1e0edf07, 0x1e104f07, 0x1e11bf07
.long 0x221a6707, 0x221bef07, 0x1e1d6f07, 0x1e1edf07
.long 0x2c400010, 0x2c41bf10, 0x28436f10, 0x28450f10
.long 0x284de000, 0x284f8f00, 0x28512f00, 0x2852cf00
.long 0x3c5ba000, 0x10df303, 0x385d9f00, 0x385f7f00
.long 0x2c800111, 0x2c81bf11, 0x2c836f11, 0x28851f11
.long 0x1d2dc303, 0x3c8df101, 0x192f3f03, 0x19309f03
.long 0x2895b101, 0x28975f01, 0x2898ff01, 0x249a9f01
.long 0x24a36101, 0x31cdc606, 0x24a4ff01, 0x24a68f01
.long 0x2cc00212, 0x2cc1bf12, 0x2cc36f12, 0x28c51f12
.long 0x28cdf202, 0x28cf9f02, 0x28d13f02, 0x28d2df02
.long 0x28dbb202, 0x28dd5f02, 0x28deff02, 0x28e09f02
.long 0x34e97202, 0x94df404, 0x34eb4f02, 0x30ed1f02
.long 0x2d000313, 0x2d01bf13, 0x2d036f13, 0x29051f13
.long 0x29125303, 0x2913ff03, 0x29159f03, 0x25173f03
.long 0x29200303, 0x2921af03, 0x29234f03, 0x2924ef03
.long 0x2d400414, 0x2d41bf14, 0x2d436f14, 0x29451f14
.long 0x29565404, 0x2957ff04, 0x29599f04, 0x255b3f04
.long 0x29640404, 0x2965af04, 0x29674f04, 0x2968ef04
.long 0x3171c404, 0x198de505, 0x2d738f04, 0x2d753f04
.long 0x2d800515, 0x2d81bf15, 0x29836f15, 0x29850f15
.long 0x2994b505, 0x29965f05, 0x2997ff05, 0x25999f05
.long 0x29a26505, 0x29a40f05, 0x25a5af05, 0x25a73f05
.long 0x29b00505, 0x29b1af05, 0x25b34f05, 0x25b4df05
.long 0x29c00616, 0x29c1af16, 0x29c34f16, 0x29c4ef16
.long 0x29d4f606, 0x29d69f06, 0x25d83f06, 0x25d9cf06
.size first_table, 512
.type L_go,@function
L_go:
    s_waitcnt lgkmcnt(0)
    s_mov_b64 s[4:5], s[14:15]
    s_and_b32 s40, s42, 0x3fff000
    s_add_u32 s40, s40, s60
    buffer_load_dwordx4 v[64:67], v4, s[4:7], s40 offen offset:0 nt
    buffer_load_dwordx4 v[68:71], v4, s[4:7], s40 offen offset:128 nt
    buffer_load_dwordx4 v[72:75], v4, s[4:7], s40 offen offset:256 nt
    buffer_load_dwordx4 v[76:79], v4, s[4:7], s40 offen offset:384 nt
    s_bfe_u32 s58, s42, 0x40008
    s_cmp_ge_u32 s58, 8
    s_cbranch_scc1 L_noq
    s_mov_b32 s14, 0x10000
    s_mov_b32 s15, 0x20000
    s_lshl_b32 s59, s58, 10
    s_add_u32 m0, s59, 134656
    s_lshl_b32 s59, s58, 5
    v_xor_b32 v16, s59, v16
    s_lshl_b32 s58, s58, 13
    s_add_u32 s58, s58, s63
    buffer_load_dwordx4 v16, s[12:15], s58 offen lds
    s_bitcmp0_b32 s42, 5
    s_cbranch_scc1 L_noq
    s_add_u32 m0, m0, 0x1000
    v_xor_b32 v16, 0x80, v16
    s_add_u32 s58, s58, 0x8000
    buffer_load_dwordx4 v16, s[12:15], s58 offen lds
L_noq:
    buffer_load_dwordx4 v[80:83], v5, s[4:7], s40 offen offset:0 nt
    buffer_load_dwordx4 v[84:87], v5, s[4:7], s40 offen offset:128 nt
    buffer_load_dwordx4 v[88:91], v5, s[4:7], s40 offen offset:256 nt
    buffer_load_dwordx4 v[92:95], v5, s[4:7], s40 offen offset:384 nt
    s_load_dwordx8 s[48:55], s[0:1], 16
    s_load_dwordx2 s[28:29], s[0:1], 56
    s_load_dword s43, s[38:39], s71 offset:4
    s_lshr_b32 s41, s42, 26
    v_cmp_gt_u32 vcc, s41, v24
    v_cmp_gt_u32 s[58:59], s41, v28
    s_add_u32 s62, s40, 0x10000
    s_lshl_b32 s79, s3, 2
    v_cndmask_b32 v10, v27, v4, vcc
    v_cndmask_b32 v11, v27, v5, s[58:59]
    buffer_load_dwordx4 v[96:99], v10, s[4:7], s62 offen offset:0 nt
    buffer_load_dwordx4 v[100:103], v10, s[4:7], s62 offen offset:128 nt
    buffer_load_dwordx4 v[104:107], v10, s[4:7], s62 offen offset:256 nt
    buffer_load_dwordx4 v[108:111], v10, s[4:7], s62 offen offset:384 nt
    buffer_load_dwordx4 v[112:115], v11, s[4:7], s62 offen offset:0 nt
    buffer_load_dwordx4 v[116:119], v11, s[4:7], s62 offen offset:128 nt
    buffer_load_dwordx4 v[120:123], v11, s[4:7], s62 offen offset:256 nt
    buffer_load_dwordx4 v[124:127], v11, s[4:7], s62 offen offset:384 nt
    s_bitcmp0_b32 s42, 4
    s_cbranch_scc1 L_nobt
    s_lshl_b32 s58, s3, 9
    s_waitcnt lgkmcnt(0)
    s_mov_b64 s[16:17], s[50:51]
    buffer_load_dwordx2 v[18:19], v25, s[16:19], s58 offen
    s_load_dword s96, s[52:53], s79
L_nobt:
    s_barrier
    s_waitcnt lgkmcnt(0)
    s_mov_b64 s[8:9], s[48:49]
    s_mov_b64 s[16:17], s[50:51]
    s_mov_b64 s[36:37], s[52:53]
    s_mov_b64 s[20:21], s[54:55]
    s_and_b32 s77, s43, 15
    s_lshl3_add_u32 s24, s44, s77
    s_lshl_b32 s24, s24, 8
    s_add_u32 s24, s24, 1179648
    s_load_dword s25, s[28:29], s24
    v_add_u32 v7, 0x1000, v6
    v_add_u32 v8, 0x8000, v6
    v_add_u32 v9, 0x9000, v6
    v_lshlrev_b32 v28, 1, v3
    v_add_u32 v29, 1, v28
    v_add_u32 v30, 8, v28
    v_add_u32 v31, 9, v28
    v_cmp_gt_u32 s[50:51], s41, v28
    v_cmp_gt_u32 s[52:53], s41, v29
    v_cmp_gt_u32 s[54:55], s41, v30
    v_cmp_gt_u32 s[56:57], s41, v31
    s_and_b32 s45, s42, 15
    s_bfe_u32 s46, s42, 0x20004
    s_bfe_u32 s47, s43, 0x40004
    v_cndmask_b32 v12, v27, v6, s[50:51]
    v_cndmask_b32 v13, v27, v7, s[52:53]
    v_cndmask_b32 v14, v27, v8, s[54:55]
    v_cndmask_b32 v15, v27, v9, s[56:57]
    s_mov_b32 s22, 0x10000
    s_mov_b32 s23, 0x20000
    s_mov_b32 s30, 2375680
    s_mov_b32 s31, 0x20000
    s_mov_b32 s49, 0x3db8aa3b
    s_mul_i32 s32, s44, 147456
    s_bfe_u32 s58, s43, 0x70014
    s_add_u32 s58, s58, 2
    s_lshl_b32 s58, s58, 11
    s_add_u32 s61, s32, s58
    s_lshl_b32 s77, s77, 9
    s_add_u32 s33, s32, s77
    v_lshlrev_b32 v17, 4, v1
    v_mov_b32 v244, 0xf1800000
    s_waitcnt lgkmcnt(0)
    s_add_u32 s25, s25, 1
    s_and_b32 s26, s25, 0xff
    v_mov_b32 v245, s26
    v_mov_b32 v11, s25
    s_mov_b32 s27, 0xffffff00
    s_getreg_b32 s26, hwreg(HW_REG_XCC_ID, 0, 4)
    s_lshl_b32 s26, s26, 28
    s_xor_b32 s26, s26, s25
    s_cmp_ge_u32 s3, 4
    s_cbranch_scc1 L_qok
    v_mov_b32 v24, 134208
    v_mov_b32 v25, 1
    s_waitcnt vmcnt(12)
    s_mov_b64 exec, 1
    ds_add_u32 v24, v25 offset:4
    s_mov_b64 exec, -1
L_qw:
    ds_read_b32 v25, v24 offset:4
    s_waitcnt lgkmcnt(0)
    v_cmp_gt_u32 vcc, 4, v25
    s_cbranch_vccnz L_qw
L_qok:
    s_cmp_eq_u32 s46, 2
    s_cbranch_scc1 L_shared
    s_lshl_b32 s58, s45, 13
    s_add_u32 s63, s63, s58
    s_lshl_b32 s58, s45, 1
    v_lshrrev_b32 v16, 3, v2
    v_add_u32 v16, s58, v16
    v_xor_b32 v24, v16, v26
    v_lshlrev_b32 v24, 4, v24
    v_lshl_add_u32 v16, v16, 9, v24
    v_add_u32 v16, 134656, v16
    v_xor_b32 v24, 0x80, v16
    ds_read_b128 v[32:35], v16 offset:0
    ds_read_b128 v[36:39], v24 offset:0
    ds_read_b128 v[40:43], v16 offset:256
    ds_read_b128 v[44:47], v24 offset:256
    v_and_b32 v24, 1, v1
    v_lshlrev_b32 v24, 4, v24
    v_mov_b32 v25, 0xffff
    v_lshlrev_b32 v25, v24, v25
    v_bfe_u32 v24, v1, 1, 2
    v_cmp_eq_u32 s[64:65], 0, v24
    v_cmp_eq_u32 s[66:67], 1, v24
    v_cmp_eq_u32 s[68:69], 2, v24
    v_cmp_eq_u32 s[70:71], 3, v24
    s_nop 0
    v_cndmask_b32 v20, 0, v25, s[64:65]
    v_cndmask_b32 v21, 0, v25, s[66:67]
    v_cndmask_b32 v22, 0, v25, s[68:69]
    v_cndmask_b32 v23, 0, v25, s[70:71]
    v_lshrrev_b32 v27, 3, v2
    v_mul_u32_u24 v24, 1040, v27
    v_and_b32 v25, 7, v1
    v_lshl_or_b32 v26, v3, 3, v25
    s_mul_i32 s58, s3, 16640
    v_lshl_add_u32 v30, v26, 4, v24
    v_add_u32 v16, s58, v30
    v_lshlrev_b32 v28, 2, v25
    v_add_u32 v28, 134144, v28
    s_cmp_eq_u32 s46, 1
    s_cbranch_scc1 L_cprep
    s_bfe_u32 s64, s43, 0x80008
    s_ff1_i32_b32 s65, s64
    v_lshrrev_b32 v24, v25, s64
    v_and_b32 v24, 1, v24
    v_cmp_eq_u32 s[66:67], 1, v24
    v_lshlrev_b32 v17, 4, v26
    v_lshl_or_b32 v17, v27, 10, v17
    v_mov_b32 v26, s65
    v_cndmask_b32 v25, v26, v25, s[66:67]
    v_lshl_or_b32 v29, v27, 6, v25
    v_lshlrev_b32 v29, 3, v29
    v_add_u32 v29, 133120, v29
    v_lshlrev_b32 v10, 5, v1
    s_lshl4_add_u32 s77, s47, s33
    s_bitcmp1_b32 s64, 0
    s_cselect_b32 s58, 0, s65
    s_mul_i32 s58, s58, 16640
    v_add_u32 v56, s58, v30
    s_bitcmp1_b32 s64, 1
    s_cselect_b32 s58, 1, s65
    s_mul_i32 s58, s58, 16640
    v_add_u32 v57, s58, v30
    s_bitcmp1_b32 s64, 2
    s_cselect_b32 s58, 2, s65
    s_mul_i32 s58, s58, 16640
    v_add_u32 v58, s58, v30
    s_bitcmp1_b32 s64, 3
    s_cselect_b32 s58, 3, s65
    s_mul_i32 s58, s58, 16640
    v_add_u32 v59, s58, v30
    s_bitcmp1_b32 s64, 4
    s_cselect_b32 s58, 4, s65
    s_mul_i32 s58, s58, 16640
    v_add_u32 v60, s58, v30
    s_bitcmp1_b32 s64, 5
    s_cselect_b32 s58, 5, s65
    s_mul_i32 s58, s58, 16640
    v_add_u32 v61, s58, v30
    s_bitcmp1_b32 s64, 6
    s_cselect_b32 s58, 6, s65
    s_mul_i32 s58, s58, 16640
    v_add_u32 v62, s58, v30
    s_branch L_prepped
L_cprep:
    s_and_b32 s78, s3, 1
    s_lshr_b32 s65, s3, 1
    s_lshl_b32 s76, s78, 10
    s_add_u32 s76, s76, s61
    s_lshl_b32 s77, s78, 8
    s_add_u32 s77, s77, s33
    s_lshl_b32 s58, s78, 9
    s_add_u32 s58, s58, 133120
    v_lshl_add_u32 v29, v25, 3, s58
    s_mul_i32 s59, s78, 1040
    s_lshl_b32 s58, s65, 8
    v_lshl_add_u32 v56, v1, 2, s58
    v_add_u32 v30, s59, v56
    v_add_u32 v31, 66560, v30
    v_add_u32 v57, 4096, v56
    v_add_u32 v58, 8192, v56
    v_add_u32 v59, 12288, v56
    v_add_u32 v60, 16384, v56
    v_and_b32 v10, 32, v1
    v_and_b32 v26, 3, v1
    v_lshl_or_b32 v10, v26, 3, v10
    v_bfe_u32 v26, v1, 2, 3
    v_or_b32 v10, v10, v26
    v_lshlrev_b32 v10, 1, v10
    s_lshl_b32 s58, s78, 6
    s_add_u32 s58, s58, 134272
    v_lshl_add_u32 v62, v2, 2, s58
    v_lshlrev_b32 v61, 4, v2
    v_cmp_gt_u32 s[74:75], s47, v2
    v_cmp_gt_u32 s[98:99], s47, v2
    v_cmp_eq_u32 s[68:69], 15, v2
    s_lshl_b32 s58, s65, 7
    s_lshl_b32 s59, s78, 9
    s_add_u32 s73, s63, s58
    s_add_u32 s73, s73, s59
L_prepped:
    s_waitcnt vmcnt(8) lgkmcnt(0)
    v_mfma_f32_16x16x32_bf16 v[192:195], v[64:67], v[32:35], 0
    v_mfma_f32_16x16x32_bf16 v[196:199], v[80:83], v[32:35], 0
    v_mfma_f32_16x16x32_bf16 v[192:195], v[68:71], v[36:39], v[192:195]
    v_mfma_f32_16x16x32_bf16 v[196:199], v[84:87], v[36:39], v[196:199]
    v_mfma_f32_16x16x32_bf16 v[192:195], v[72:75], v[40:43], v[192:195]
    v_mfma_f32_16x16x32_bf16 v[196:199], v[88:91], v[40:43], v[196:199]
    v_mfma_f32_16x16x32_bf16 v[192:195], v[76:79], v[44:47], v[192:195]
    v_mfma_f32_16x16x32_bf16 v[196:199], v[92:95], v[44:47], v[196:199]
    s_nop 7
    v_mov_b32_dpp v235, v192 quad_perm:[0,0,2,2] row_mask:0xf bank_mask:0xf
    v_add_f32_dpp v224, v193, v235 quad_perm:[1,1,3,3] row_mask:0xf bank_mask:0xf
    v_mov_b32_dpp v235, v194 quad_perm:[0,0,2,2] row_mask:0xf bank_mask:0xf
    v_add_f32_dpp v225, v195, v235 quad_perm:[1,1,3,3] row_mask:0xf bank_mask:0xf
    v_mov_b32_dpp v235, v196 quad_perm:[0,0,2,2] row_mask:0xf bank_mask:0xf
    v_add_f32_dpp v226, v197, v235 quad_perm:[1,1,3,3] row_mask:0xf bank_mask:0xf
    v_mov_b32_dpp v235, v198 quad_perm:[0,0,2,2] row_mask:0xf bank_mask:0xf
    v_add_f32_dpp v227, v199, v235 quad_perm:[1,1,3,3] row_mask:0xf bank_mask:0xf
    s_waitcnt vmcnt(0)
    v_mfma_f32_16x16x32_bf16 v[200:203], v[96:99], v[32:35], 0
    v_mfma_f32_16x16x32_bf16 v[204:207], v[112:115], v[32:35], 0
    v_mfma_f32_16x16x32_bf16 v[200:203], v[100:103], v[36:39], v[200:203]
    v_mfma_f32_16x16x32_bf16 v[204:207], v[116:119], v[36:39], v[204:207]
    v_mfma_f32_16x16x32_bf16 v[200:203], v[104:107], v[40:43], v[200:203]
    v_mfma_f32_16x16x32_bf16 v[204:207], v[120:123], v[40:43], v[204:207]
    v_mfma_f32_16x16x32_bf16 v[200:203], v[108:111], v[44:47], v[200:203]
    v_mfma_f32_16x16x32_bf16 v[204:207], v[124:127], v[44:47], v[204:207]
    s_lshl_b32 s58, s3, 6
    v_lshrrev_b32 v24, 5, v1
    v_lshlrev_b32 v25, 1, v1
    v_mad_u32_u24 v24, v24, s58, v25
    v_add_u32 v25, 1, v24
    v_cmp_ne_u32 vcc, v24, v18
    v_cmp_ne_u32 s[58:59], v25, v19
    s_add_u32 s72, s3, 1
    s_mul_i32 s72, s72, 433
    s_and_b32 s72, s72, 511
    s_sub_u32 s72, 0x800, s72
    s_or_b64 vcc, vcc, s[58:59]
    s_or_b32 s58, vcc_lo, vcc_hi
    s_xor_b32 s72, s72, s96
    s_or_b32 s72, s72, s58
    v_mov_b32_dpp v235, v200 quad_perm:[0,0,2,2] row_mask:0xf bank_mask:0xf
    v_add_f32_dpp v228, v201, v235 quad_perm:[1,1,3,3] row_mask:0xf bank_mask:0xf
    v_mov_b32_dpp v235, v202 quad_perm:[0,0,2,2] row_mask:0xf bank_mask:0xf
    v_add_f32_dpp v229, v203, v235 quad_perm:[1,1,3,3] row_mask:0xf bank_mask:0xf
    v_mov_b32_dpp v235, v204 quad_perm:[0,0,2,2] row_mask:0xf bank_mask:0xf
    v_add_f32_dpp v230, v205, v235 quad_perm:[1,1,3,3] row_mask:0xf bank_mask:0xf
    v_mov_b32_dpp v235, v206 quad_perm:[0,0,2,2] row_mask:0xf bank_mask:0xf
    v_add_f32_dpp v231, v207, v235 quad_perm:[1,1,3,3] row_mask:0xf bank_mask:0xf
    v_cndmask_b32 v228, v244, v228, s[50:51]
    v_cndmask_b32 v229, v244, v229, s[52:53]
    v_cndmask_b32 v230, v244, v230, s[54:55]
    v_cndmask_b32 v231, v244, v231, s[56:57]
    v_max3_f32 v232, v224, v225, v226
    v_max3_f32 v235, v227, v228, v229
    v_max3_f32 v232, v232, v230, v231
    v_max_f32 v232, v232, v235
    v_mov_b32 v234, v232
    s_nop 1
    v_permlane16_swap_b32 v232, v234
    v_max_f32 v232, v232, v234
    v_mov_b32 v234, v232
    s_nop 1
    v_permlane32_swap_b32 v232, v234
    v_max_f32 v232, v232, v234
    v_mul_f32 v232, s49, v232
    v_fma_f32 v224, v224, s49, -v232
    v_fma_f32 v225, v225, s49, -v232
    v_fma_f32 v226, v226, s49, -v232
    v_fma_f32 v227, v227, s49, -v232
    v_fma_f32 v228, v228, s49, -v232
    v_fma_f32 v229, v229, s49, -v232
    v_fma_f32 v230, v230, s49, -v232
    v_fma_f32 v231, v231, s49, -v232
    v_exp_f32 v224, v224
    v_exp_f32 v225, v225
    v_exp_f32 v226, v226
    v_exp_f32 v227, v227
    v_exp_f32 v228, v228
    v_exp_f32 v229, v229
    v_exp_f32 v230, v230
    v_exp_f32 v231, v231
    v_add_f32 v233, v224, v225
    v_add_f32 v235, v226, v227
    v_add_f32 v233, v233, v228
    v_add_f32 v235, v235, v229
    v_add_f32 v233, v233, v230
    v_add_f32 v235, v235, v231
    v_add_f32 v233, v233, v235
    v_mov_b32 v234, v233
    s_nop 1
    v_permlane16_swap_b32 v233, v234
    v_add_f32 v233, v233, v234
    v_mov_b32 v234, v233
    s_nop 1
    v_permlane32_swap_b32 v233, v234
    v_add_f32 v233, v233, v234
    v_lshlrev_b32 v24, 6, v2
    s_lshl_b32 s58, s3, 3
    s_add_u32 s58, s58, 133120
    v_add_u32 v24, s58, v24
    ds_write_b64 v24, v[232:233]
    s_lshl_b32 s58, s3, 2
    s_add_u32 s58, s58, 134144
    v_mov_b32 v25, s58
    v_mov_b32 v26, s72
    ds_write_b32 v25, v26
    s_waitcnt lgkmcnt(0)
    s_barrier
    s_lshl4_add_u32 s58, s46, s3
    s_cmp_eq_u32 s58, 7
    s_cbranch_scc1 L_last
    buffer_load_dwordx4 v[128:131], v6, s[8:11], s40 offen offset:0 nt
    buffer_load_dwordx4 v[132:135], v6, s[8:11], s40 offen offset:256 nt
    buffer_load_dwordx4 v[136:139], v7, s[8:11], s40 offen offset:0 nt
    buffer_load_dwordx4 v[140:143], v7, s[8:11], s40 offen offset:256 nt
    v_cvt_pk_bf16_f32 v224, v224, v224
    v_cvt_pk_bf16_f32 v225, v225, v225
    v_cvt_pk_bf16_f32 v226, v226, v226
    v_cvt_pk_bf16_f32 v227, v227, v227
    v_cvt_pk_bf16_f32 v228, v228, v228
    v_cvt_pk_bf16_f32 v229, v229, v229
    v_cvt_pk_bf16_f32 v230, v230, v230
    v_cvt_pk_bf16_f32 v231, v231, v231
    v_and_b32 v64, v224, v20
    v_and_b32 v65, v224, v21
    v_and_b32 v66, v224, v22
    v_and_b32 v67, v224, v23
    v_and_b32 v68, v225, v20
    v_and_b32 v69, v225, v21
    buffer_load_dwordx4 v[144:147], v8, s[8:11], s40 offen offset:0 nt
    buffer_load_dwordx4 v[148:151], v8, s[8:11], s40 offen offset:256 nt
    buffer_load_dwordx4 v[152:155], v9, s[8:11], s40 offen offset:0 nt
    buffer_load_dwordx4 v[156:159], v9, s[8:11], s40 offen offset:256 nt
    v_and_b32 v70, v225, v22
    v_and_b32 v71, v225, v23
    v_and_b32 v72, v226, v20
    v_and_b32 v73, v226, v21
    v_and_b32 v74, v226, v22
    v_and_b32 v75, v226, v23
    v_and_b32 v76, v227, v20
    v_and_b32 v77, v227, v21
    v_and_b32 v78, v227, v22
    v_and_b32 v79, v227, v23
    v_and_b32 v80, v228, v20
    v_and_b32 v81, v228, v21
    v_and_b32 v82, v228, v22
    v_and_b32 v83, v228, v23
    buffer_load_dwordx4 v[160:163], v12, s[8:11], s62 offen offset:0 nt
    buffer_load_dwordx4 v[164:167], v12, s[8:11], s62 offen offset:256 nt
    buffer_load_dwordx4 v[168:171], v13, s[8:11], s62 offen offset:0 nt
    buffer_load_dwordx4 v[172:175], v13, s[8:11], s62 offen offset:256 nt
    v_and_b32 v84, v229, v20
    v_and_b32 v85, v229, v21
    v_and_b32 v86, v229, v22
    v_and_b32 v87, v229, v23
    v_and_b32 v88, v230, v20
    v_and_b32 v89, v230, v21
    v_and_b32 v90, v230, v22
    v_and_b32 v91, v230, v23
    v_and_b32 v92, v231, v20
    v_and_b32 v93, v231, v21
    v_and_b32 v94, v231, v22
    v_and_b32 v95, v231, v23
    buffer_load_dwordx4 v[176:179], v14, s[8:11], s62 offen offset:0 nt
    buffer_load_dwordx4 v[180:183], v14, s[8:11], s62 offen offset:256 nt
    buffer_load_dwordx4 v[184:187], v15, s[8:11], s62 offen offset:0 nt
    buffer_load_dwordx4 v[188:191], v15, s[8:11], s62 offen offset:256 nt
    s_cmp_lt_u32 s3, 4
    s_cbranch_scc1 L_isp
    v_mov_b32 v24, 134208
    v_mov_b32 v25, 1
    s_mov_b64 exec, 1
    ds_add_u32 v24, v25
    s_mov_b64 exec, -1
L_isp:
    s_cmp_ge_u32 s3, 4
    s_cbranch_scc1 L_pw
    s_barrier
L_pw:
    s_bitcmp0_b32 s43, 16
    s_cbranch_scc1 L_pwe
    s_cmp_eq_u32 s46, 1
    s_cbranch_scc1 L_cw
    s_load_dword s34, s[28:29], s24 offset:128
    ds_read_b64 v[232:233], v29
    s_waitcnt lgkmcnt(0)
    v_max_f32_dpp v234, v232, v232 quad_perm:[1,0,3,2] row_mask:0xf bank_mask:0xf
    s_nop 1
    v_max_f32_dpp v234, v234, v234 quad_perm:[2,3,0,1] row_mask:0xf bank_mask:0xf
    s_nop 1
    v_max_f32_dpp v234, v234, v234 row_half_mirror row_mask:0xf bank_mask:0xf
    v_sub_f32 v224, v232, v234
    v_exp_f32 v224, v224
    s_nop 0
    v_cndmask_b32 v224, 0, v224, s[66:67]
    v_mul_f32 v235, v224, v233
    s_nop 1
    v_add_f32_dpp v235, v235, v235 quad_perm:[1,0,3,2] row_mask:0xf bank_mask:0xf
    s_nop 1
    v_add_f32_dpp v235, v235, v235 quad_perm:[2,3,0,1] row_mask:0xf bank_mask:0xf
    s_nop 1
    v_add_f32_dpp v235, v235, v235 row_half_mirror row_mask:0xf bank_mask:0xf
    v_mov_b32_dpp v48, v224 row_newbcast:0 row_mask:0xf bank_mask:0x3
    v_mov_b32_dpp v48, v224 row_newbcast:8 row_mask:0xf bank_mask:0xc
    v_mov_b32_dpp v49, v224 row_newbcast:1 row_mask:0xf bank_mask:0x3
    v_mov_b32_dpp v49, v224 row_newbcast:9 row_mask:0xf bank_mask:0xc
    v_mov_b32_dpp v50, v224 row_newbcast:2 row_mask:0xf bank_mask:0x3
    v_mov_b32_dpp v50, v224 row_newbcast:10 row_mask:0xf bank_mask:0xc
    v_mov_b32_dpp v51, v224 row_newbcast:3 row_mask:0xf bank_mask:0x3
    v_mov_b32_dpp v51, v224 row_newbcast:11 row_mask:0xf bank_mask:0xc
    v_mov_b32_dpp v52, v224 row_newbcast:4 row_mask:0xf bank_mask:0x3
    v_mov_b32_dpp v52, v224 row_newbcast:12 row_mask:0xf bank_mask:0xc
    v_mov_b32_dpp v53, v224 row_newbcast:5 row_mask:0xf bank_mask:0x3
    v_mov_b32_dpp v53, v224 row_newbcast:13 row_mask:0xf bank_mask:0xc
    v_mov_b32_dpp v54, v224 row_newbcast:6 row_mask:0xf bank_mask:0x3
    v_mov_b32_dpp v54, v224 row_newbcast:14 row_mask:0xf bank_mask:0xc
    v_mov_b32_dpp v55, v224 row_newbcast:7 row_mask:0xf bank_mask:0x3
    v_mov_b32_dpp v55, v224 row_newbcast:15 row_mask:0xf bank_mask:0xc
    s_mov_b32 s58, 0x04020100
    v_perm_b32 v236, v234, v11, s58
    v_and_or_b32 v234, v234, s27, v245
    v_and_or_b32 v235, v235, s27, v245
    s_branch L_py
L_cw:
    ds_read_b32 v24, v28
    ds_read_b64 v[232:233], v29
    s_waitcnt lgkmcnt(0)
    v_cmp_ne_u32 vcc, 0, v24
    v_max_f32_dpp v234, v232, v232 quad_perm:[1,0,3,2] row_mask:0xf bank_mask:0xf
    s_cbranch_vccnz L_mismatch
    s_nop 0
    v_max_f32_dpp v234, v234, v234 quad_perm:[2,3,0,1] row_mask:0xf bank_mask:0xf
    s_nop 1
    v_max_f32_dpp v234, v234, v234 row_half_mirror row_mask:0xf bank_mask:0xf
    v_sub_f32 v224, v232, v234
    v_exp_f32 v224, v224
    s_nop 0
    v_mul_f32 v235, v224, v233
    s_nop 1
    v_add_f32_dpp v235, v235, v235 quad_perm:[1,0,3,2] row_mask:0xf bank_mask:0xf
    s_nop 1
    v_add_f32_dpp v235, v235, v235 quad_perm:[2,3,0,1] row_mask:0xf bank_mask:0xf
    s_nop 1
    v_add_f32_dpp v235, v235, v235 row_half_mirror row_mask:0xf bank_mask:0xf
    v_cndmask_b32 v235, 0, v235, s[68:69]
    v_mov_b32 v112, v245
    v_mov_b32 v113, v245
    v_mov_b32 v114, v245
    v_mov_b32 v115, v245
    v_mov_b32 v116, v245
    v_mov_b32 v117, v245
    v_mov_b32 v118, v245
    v_mov_b32 v119, v245
    v_mov_b32 v120, v245
    s_mov_b32 s59, 0x100000
    s_mov_b32 s35, 0x07060503
    s_add_u32 s79, s77, 1196032
    s_xor_b32 s79, s79, s77
L_pwe:
    s_cmp_ge_u32 s3, 4
    s_cbranch_scc1 L_px
L_py:
    s_cmp_eq_u32 s41, -1
    s_cbranch_scc1 L_pwrite
    s_waitcnt vmcnt(14)
    v_mfma_f32_16x16x32_bf16 v[208:211], v[128:131], v[64:67], 0
    v_mfma_f32_16x16x32_bf16 v[212:215], v[132:135], v[64:67], 0
    s_waitcnt vmcnt(12)
    v_mfma_f32_16x16x32_bf16 v[208:211], v[136:139], v[68:71], v[208:211]
    v_mfma_f32_16x16x32_bf16 v[212:215], v[140:143], v[68:71], v[212:215]
    s_waitcnt vmcnt(10)
    v_mfma_f32_16x16x32_bf16 v[208:211], v[144:147], v[72:75], v[208:211]
    v_mfma_f32_16x16x32_bf16 v[212:215], v[148:151], v[72:75], v[212:215]
    s_waitcnt vmcnt(8)
    v_mfma_f32_16x16x32_bf16 v[208:211], v[152:155], v[76:79], v[208:211]
    v_mfma_f32_16x16x32_bf16 v[212:215], v[156:159], v[76:79], v[212:215]
    s_waitcnt vmcnt(6)
    v_mfma_f32_16x16x32_bf16 v[208:211], v[160:163], v[80:83], v[208:211]
    v_mfma_f32_16x16x32_bf16 v[212:215], v[164:167], v[80:83], v[212:215]
    s_waitcnt vmcnt(4)
    v_mfma_f32_16x16x32_bf16 v[208:211], v[168:171], v[84:87], v[208:211]
    v_mfma_f32_16x16x32_bf16 v[212:215], v[172:175], v[84:87], v[212:215]
    s_waitcnt vmcnt(2)
    v_mfma_f32_16x16x32_bf16 v[208:211], v[176:179], v[88:91], v[208:211]
    v_mfma_f32_16x16x32_bf16 v[212:215], v[180:183], v[88:91], v[212:215]
    s_waitcnt vmcnt(0)
    v_mfma_f32_16x16x32_bf16 v[208:211], v[184:187], v[92:95], v[208:211]
    v_mfma_f32_16x16x32_bf16 v[212:215], v[188:191], v[92:95], v[212:215]
    s_nop 6
L_pwrite:
    ds_write_b128 v16, v[208:211]
    ds_write_b128 v16, v[212:215] offset:512
    s_cmp_ge_u32 s3, 4
    s_cbranch_scc1 L_pb
    s_cmp_eq_u32 s46, 1
    s_cbranch_scc1 L_cml
    s_bitcmp0_b32 s43, 16
    s_cbranch_scc1 L_px
    s_mov_b64 exec, 0x101
    s_cmp_lg_u32 s34, s26
    s_cbranch_scc1 L_mfa
L_mna:
    buffer_store_dwordx3 v[234:236], v10, s[28:31], s77 offen
L_mda:
    s_mov_b64 exec, -1
    s_branch L_px
L_cml:
    s_cmp_ge_u32 s3, 2
    s_cbranch_scc1 L_px
    buffer_load_dwordx3 v[246:248], v61, s[28:31], s77 offen sc1
L_px:
    s_waitcnt lgkmcnt(0)
    s_barrier
    s_cmp_eq_u32 s46, 1
    s_cbranch_scc1 L_cpre
    s_bitcmp0_b32 s43, 16
    s_cbranch_scc1 L_pxe
    ds_read_b128 v[96:99], v56 offset:0
    ds_read_b128 v[100:103], v56 offset:512
    ds_read_b128 v[104:107], v57 offset:0
    ds_read_b128 v[108:111], v57 offset:512
    ds_read_b128 v[112:115], v58 offset:0
    ds_read_b128 v[116:119], v58 offset:512
    ds_read_b128 v[120:123], v59 offset:0
    ds_read_b128 v[124:127], v59 offset:512
    s_waitcnt lgkmcnt(0)
    v_mul_f32 v216, v48, v96
    v_mul_f32 v217, v48, v97
    v_mul_f32 v218, v48, v98
    v_mul_f32 v219, v48, v99
    v_mul_f32 v220, v48, v100
    v_mul_f32 v221, v48, v101
    v_mul_f32 v222, v48, v102
    v_mul_f32 v223, v48, v103
    v_fmac_f32 v216, v49, v104
    v_fmac_f32 v217, v49, v105
    v_fmac_f32 v218, v49, v106
    v_fmac_f32 v219, v49, v107
    v_fmac_f32 v220, v49, v108
    v_fmac_f32 v221, v49, v109
    v_fmac_f32 v222, v49, v110
    v_fmac_f32 v223, v49, v111
    v_fmac_f32 v216, v50, v112
    v_fmac_f32 v217, v50, v113
    v_fmac_f32 v218, v50, v114
    v_fmac_f32 v219, v50, v115
    v_fmac_f32 v220, v50, v116
    v_fmac_f32 v221, v50, v117
    v_fmac_f32 v222, v50, v118
    v_fmac_f32 v223, v50, v119
    v_fmac_f32 v216, v51, v120
    v_fmac_f32 v217, v51, v121
    v_fmac_f32 v218, v51, v122
    v_fmac_f32 v219, v51, v123
    v_fmac_f32 v220, v51, v124
    v_fmac_f32 v221, v51, v125
    v_fmac_f32 v222, v51, v126
    v_fmac_f32 v223, v51, v127
    s_barrier
    ds_read_b128 v[96:99], v60 offset:0
    ds_read_b128 v[100:103], v60 offset:512
    ds_read_b128 v[104:107], v61 offset:0
    ds_read_b128 v[108:111], v61 offset:512
    ds_read_b128 v[112:115], v62 offset:0
    ds_read_b128 v[116:119], v62 offset:512
    s_waitcnt lgkmcnt(0)
    v_fmac_f32 v216, v52, v96
    v_fmac_f32 v217, v52, v97
    v_fmac_f32 v218, v52, v98
    v_fmac_f32 v219, v52, v99
    v_fmac_f32 v220, v52, v100
    v_fmac_f32 v221, v52, v101
    v_fmac_f32 v222, v52, v102
    v_fmac_f32 v223, v52, v103
    v_fmac_f32 v216, v53, v104
    v_fmac_f32 v217, v53, v105
    v_fmac_f32 v218, v53, v106
    v_fmac_f32 v219, v53, v107
    v_fmac_f32 v220, v53, v108
    v_fmac_f32 v221, v53, v109
    v_fmac_f32 v222, v53, v110
    v_fmac_f32 v223, v53, v111
    v_fmac_f32 v216, v54, v112
    v_fmac_f32 v217, v54, v113
    v_fmac_f32 v218, v54, v114
    v_fmac_f32 v219, v54, v115
    v_fmac_f32 v220, v54, v116
    v_fmac_f32 v221, v54, v117
    v_fmac_f32 v222, v54, v118
    v_fmac_f32 v223, v54, v119
    s_cmp_lg_u32 s34, s26
    v_and_or_b32 v216, v216, s27, v245
    v_and_or_b32 v217, v217, s27, v245
    v_and_or_b32 v218, v218, s27, v245
    v_and_or_b32 v219, v219, s27, v245
    s_cbranch_scc1 L_wta0
    buffer_store_dwordx4 v[216:219], v17, s[28:31], s61 offen offset:0
L_puta0:
    v_and_or_b32 v220, v220, s27, v245
    v_and_or_b32 v221, v221, s27, v245
    v_and_or_b32 v222, v222, s27, v245
    v_and_or_b32 v223, v223, s27, v245
    s_cbranch_scc1 L_wta1
    buffer_store_dwordx4 v[220:223], v17, s[28:31], s61 offen offset:512
L_puta1:
    s_endpgm
L_last:
    v_cvt_pk_bf16_f32 v224, v224, v224
    v_cvt_pk_bf16_f32 v225, v225, v225
    v_cvt_pk_bf16_f32 v226, v226, v226
    v_cvt_pk_bf16_f32 v227, v227, v227
    v_cvt_pk_bf16_f32 v228, v228, v228
    v_cvt_pk_bf16_f32 v229, v229, v229
    v_cvt_pk_bf16_f32 v230, v230, v230
    v_cvt_pk_bf16_f32 v231, v231, v231
    v_and_b32 v64, v224, v20
    v_and_b32 v65, v224, v21
    v_and_b32 v66, v224, v22
    v_and_b32 v67, v224, v23
    v_and_b32 v68, v225, v20
    v_and_b32 v69, v225, v21
    v_and_b32 v70, v225, v22
    v_and_b32 v71, v225, v23
    v_and_b32 v72, v226, v20
    v_and_b32 v73, v226, v21
    v_and_b32 v74, v226, v22
    v_and_b32 v75, v226, v23
    v_and_b32 v76, v227, v20
    v_and_b32 v77, v227, v21
    v_and_b32 v78, v227, v22
    v_and_b32 v79, v227, v23
    v_and_b32 v80, v228, v20
    v_and_b32 v81, v228, v21
    v_and_b32 v82, v228, v22
    v_and_b32 v83, v228, v23
    v_and_b32 v84, v229, v20
    v_and_b32 v85, v229, v21
    v_and_b32 v86, v229, v22
    v_and_b32 v87, v229, v23
    v_and_b32 v88, v230, v20
    v_and_b32 v89, v230, v21
    v_and_b32 v90, v230, v22
    v_and_b32 v91, v230, v23
    v_and_b32 v92, v231, v20
    v_and_b32 v93, v231, v21
    v_and_b32 v94, v231, v22
    v_and_b32 v95, v231, v23
    s_load_dword s34, s[28:29], s24 offset:128
    ds_read_b64 v[232:233], v29
    s_waitcnt lgkmcnt(0)
    v_max_f32_dpp v234, v232, v232 quad_perm:[1,0,3,2] row_mask:0xf bank_mask:0xf
    s_nop 1
    v_max_f32_dpp v234, v234, v234 quad_perm:[2,3,0,1] row_mask:0xf bank_mask:0xf
    s_nop 1
    v_max_f32_dpp v234, v234, v234 row_half_mirror row_mask:0xf bank_mask:0xf
    v_sub_f32 v224, v232, v234
    v_exp_f32 v224, v224
    s_nop 0
    v_cndmask_b32 v224, 0, v224, s[66:67]
    v_mul_f32 v235, v224, v233
    s_nop 1
    v_add_f32_dpp v235, v235, v235 quad_perm:[1,0,3,2] row_mask:0xf bank_mask:0xf
    s_nop 1
    v_add_f32_dpp v235, v235, v235 quad_perm:[2,3,0,1] row_mask:0xf bank_mask:0xf
    s_nop 1
    v_add_f32_dpp v235, v235, v235 row_half_mirror row_mask:0xf bank_mask:0xf
    v_mov_b32_dpp v48, v224 row_newbcast:0 row_mask:0xf bank_mask:0x3
    v_mov_b32_dpp v48, v224 row_newbcast:8 row_mask:0xf bank_mask:0xc
    v_mov_b32_dpp v49, v224 row_newbcast:1 row_mask:0xf bank_mask:0x3
    v_mov_b32_dpp v49, v224 row_newbcast:9 row_mask:0xf bank_mask:0xc
    v_mov_b32_dpp v50, v224 row_newbcast:2 row_mask:0xf bank_mask:0x3
    v_mov_b32_dpp v50, v224 row_newbcast:10 row_mask:0xf bank_mask:0xc
    v_mov_b32_dpp v51, v224 row_newbcast:3 row_mask:0xf bank_mask:0x3
    v_mov_b32_dpp v51, v224 row_newbcast:11 row_mask:0xf bank_mask:0xc
    v_mov_b32_dpp v52, v224 row_newbcast:4 row_mask:0xf bank_mask:0x3
    v_mov_b32_dpp v52, v224 row_newbcast:12 row_mask:0xf bank_mask:0xc
    v_mov_b32_dpp v53, v224 row_newbcast:5 row_mask:0xf bank_mask:0x3
    v_mov_b32_dpp v53, v224 row_newbcast:13 row_mask:0xf bank_mask:0xc
    v_mov_b32_dpp v54, v224 row_newbcast:6 row_mask:0xf bank_mask:0x3
    v_mov_b32_dpp v54, v224 row_newbcast:14 row_mask:0xf bank_mask:0xc
    v_mov_b32_dpp v55, v224 row_newbcast:7 row_mask:0xf bank_mask:0x3
    v_mov_b32_dpp v55, v224 row_newbcast:15 row_mask:0xf bank_mask:0xc
    s_mov_b32 s58, 0x04020100
    v_perm_b32 v236, v234, v11, s58
    v_and_or_b32 v234, v234, s27, v245
    v_and_or_b32 v235, v235, s27, v245
    s_mov_b64 exec, 0x101
    s_cmp_lg_u32 s34, s26
    s_cbranch_scc1 L_mfl
L_mnl:
    buffer_store_dwordx3 v[234:236], v10, s[28:31], s77 offen
L_mdl:
    s_mov_b64 exec, -1
    v_mov_b32 v24, 134208
L_awp:
    ds_read_b32 v25, v24
    s_waitcnt lgkmcnt(0)
    v_cmp_gt_u32 vcc, 3, v25
    s_cbranch_vccnz L_awp
    buffer_load_dwordx4 v[128:131], v6, s[8:11], s40 offen offset:0 nt
    buffer_load_dwordx4 v[132:135], v6, s[8:11], s40 offen offset:256 nt
    buffer_load_dwordx4 v[136:139], v7, s[8:11], s40 offen offset:0 nt
    buffer_load_dwordx4 v[140:143], v7, s[8:11], s40 offen offset:256 nt
    buffer_load_dwordx4 v[144:147], v8, s[8:11], s40 offen offset:0 nt
    buffer_load_dwordx4 v[148:151], v8, s[8:11], s40 offen offset:256 nt
    buffer_load_dwordx4 v[152:155], v9, s[8:11], s40 offen offset:0 nt
    buffer_load_dwordx4 v[156:159], v9, s[8:11], s40 offen offset:256 nt
    buffer_load_dwordx4 v[160:163], v12, s[8:11], s62 offen offset:0 nt
    buffer_load_dwordx4 v[164:167], v12, s[8:11], s62 offen offset:256 nt
    buffer_load_dwordx4 v[168:171], v13, s[8:11], s62 offen offset:0 nt
    buffer_load_dwordx4 v[172:175], v13, s[8:11], s62 offen offset:256 nt
    buffer_load_dwordx4 v[176:179], v14, s[8:11], s62 offen offset:0 nt
    buffer_load_dwordx4 v[180:183], v14, s[8:11], s62 offen offset:256 nt
    buffer_load_dwordx4 v[184:187], v15, s[8:11], s62 offen offset:0 nt
    buffer_load_dwordx4 v[188:191], v15, s[8:11], s62 offen offset:256 nt
    s_barrier
    ds_read_b128 v[96:99], v56 offset:0
    ds_read_b128 v[100:103], v56 offset:512
    ds_read_b128 v[104:107], v57 offset:0
    ds_read_b128 v[108:111], v57 offset:512
    ds_read_b128 v[112:115], v58 offset:0
    ds_read_b128 v[116:119], v58 offset:512
    ds_read_b128 v[120:123], v59 offset:0
    ds_read_b128 v[124:127], v59 offset:512
    s_waitcnt lgkmcnt(0)
    v_mul_f32 v216, v48, v96
    v_mul_f32 v217, v48, v97
    v_mul_f32 v218, v48, v98
    v_mul_f32 v219, v48, v99
    v_mul_f32 v220, v48, v100
    v_mul_f32 v221, v48, v101
    v_mul_f32 v222, v48, v102
    v_mul_f32 v223, v48, v103
    v_fmac_f32 v216, v49, v104
    v_fmac_f32 v217, v49, v105
    v_fmac_f32 v218, v49, v106
    v_fmac_f32 v219, v49, v107
    v_fmac_f32 v220, v49, v108
    v_fmac_f32 v221, v49, v109
    v_fmac_f32 v222, v49, v110
    v_fmac_f32 v223, v49, v111
    v_fmac_f32 v216, v50, v112
    v_fmac_f32 v217, v50, v113
    v_fmac_f32 v218, v50, v114
    v_fmac_f32 v219, v50, v115
    v_fmac_f32 v220, v50, v116
    v_fmac_f32 v221, v50, v117
    v_fmac_f32 v222, v50, v118
    v_fmac_f32 v223, v50, v119
    v_fmac_f32 v216, v51, v120
    v_fmac_f32 v217, v51, v121
    v_fmac_f32 v218, v51, v122
    v_fmac_f32 v219, v51, v123
    v_fmac_f32 v220, v51, v124
    v_fmac_f32 v221, v51, v125
    v_fmac_f32 v222, v51, v126
    v_fmac_f32 v223, v51, v127
    s_cmp_lg_u32 s34, s26
    s_barrier
    ds_read_b128 v[96:99], v60 offset:0
    ds_read_b128 v[100:103], v60 offset:512
    ds_read_b128 v[104:107], v61 offset:0
    ds_read_b128 v[108:111], v61 offset:512
    ds_read_b128 v[112:115], v62 offset:0
    ds_read_b128 v[116:119], v62 offset:512
    s_waitcnt vmcnt(14)
    v_mfma_f32_16x16x32_bf16 v[208:211], v[128:131], v[64:67], 0
    v_mfma_f32_16x16x32_bf16 v[212:215], v[132:135], v[64:67], 0
    s_waitcnt lgkmcnt(4)
    v_fmac_f32 v216, v52, v96
    v_fmac_f32 v217, v52, v97
    v_fmac_f32 v218, v52, v98
    v_fmac_f32 v219, v52, v99
    v_fmac_f32 v220, v52, v100
    v_fmac_f32 v221, v52, v101
    v_fmac_f32 v222, v52, v102
    v_fmac_f32 v223, v52, v103
    s_waitcnt vmcnt(12)
    v_mfma_f32_16x16x32_bf16 v[208:211], v[136:139], v[68:71], v[208:211]
    v_mfma_f32_16x16x32_bf16 v[212:215], v[140:143], v[68:71], v[212:215]
    s_waitcnt lgkmcnt(2)
    v_fmac_f32 v216, v53, v104
    v_fmac_f32 v217, v53, v105
    v_fmac_f32 v218, v53, v106
    v_fmac_f32 v219, v53, v107
    v_fmac_f32 v220, v53, v108
    v_fmac_f32 v221, v53, v109
    v_fmac_f32 v222, v53, v110
    v_fmac_f32 v223, v53, v111
    s_waitcnt vmcnt(10)
    v_mfma_f32_16x16x32_bf16 v[208:211], v[144:147], v[72:75], v[208:211]
    v_mfma_f32_16x16x32_bf16 v[212:215], v[148:151], v[72:75], v[212:215]
    s_waitcnt lgkmcnt(0)
    v_fmac_f32 v216, v54, v112
    v_fmac_f32 v217, v54, v113
    v_fmac_f32 v218, v54, v114
    v_fmac_f32 v219, v54, v115
    v_fmac_f32 v220, v54, v116
    v_fmac_f32 v221, v54, v117
    v_fmac_f32 v222, v54, v118
    v_fmac_f32 v223, v54, v119
    s_waitcnt vmcnt(8)
    v_mfma_f32_16x16x32_bf16 v[208:211], v[152:155], v[76:79], v[208:211]
    v_mfma_f32_16x16x32_bf16 v[212:215], v[156:159], v[76:79], v[212:215]
    s_waitcnt vmcnt(6)
    v_mfma_f32_16x16x32_bf16 v[208:211], v[160:163], v[80:83], v[208:211]
    v_mfma_f32_16x16x32_bf16 v[212:215], v[164:167], v[80:83], v[212:215]
    s_waitcnt vmcnt(4)
    v_mfma_f32_16x16x32_bf16 v[208:211], v[168:171], v[84:87], v[208:211]
    v_mfma_f32_16x16x32_bf16 v[212:215], v[172:175], v[84:87], v[212:215]
    s_waitcnt vmcnt(2)
    v_mfma_f32_16x16x32_bf16 v[208:211], v[176:179], v[88:91], v[208:211]
    v_mfma_f32_16x16x32_bf16 v[212:215], v[180:183], v[88:91], v[212:215]
    s_waitcnt vmcnt(0)
    v_mfma_f32_16x16x32_bf16 v[208:211], v[184:187], v[92:95], v[208:211]
    v_mfma_f32_16x16x32_bf16 v[212:215], v[188:191], v[92:95], v[212:215]
    s_nop 6
    v_pk_fma_f32 v[216:217], v[208:209], v[54:55], v[216:217] op_sel:[0,1,0] op_sel_hi:[1,1,1]
    v_pk_fma_f32 v[218:219], v[210:211], v[54:55], v[218:219] op_sel:[0,1,0] op_sel_hi:[1,1,1]
    v_and_or_b32 v216, v216, s27, v245
    v_and_or_b32 v217, v217, s27, v245
    v_and_or_b32 v218, v218, s27, v245
    v_and_or_b32 v219, v219, s27, v245
    s_cbranch_scc1 L_wtl0
    buffer_store_dwordx4 v[216:219], v17, s[28:31], s61 offen offset:0
L_putl0:
    v_pk_fma_f32 v[220:221], v[212:213], v[54:55], v[220:221] op_sel:[0,1,0] op_sel_hi:[1,1,1]
    v_pk_fma_f32 v[222:223], v[214:215], v[54:55], v[222:223] op_sel:[0,1,0] op_sel_hi:[1,1,1]
    v_and_or_b32 v220, v220, s27, v245
    v_and_or_b32 v221, v221, s27, v245
    v_and_or_b32 v222, v222, s27, v245
    v_and_or_b32 v223, v223, s27, v245
    s_cbranch_scc1 L_wtl1
    buffer_store_dwordx4 v[220:223], v17, s[28:31], s61 offen offset:512
L_putl1:
    s_endpgm
L_cpre:
    ds_read2st64_b32 v[96:97], v30 offset0:0 offset1:65
    ds_read2st64_b32 v[98:99], v30 offset0:130 offset1:195
    s_waitcnt lgkmcnt(0)
    v_mul_f32_dpp v216, v224, v96 row_newbcast:0 row_mask:0xf bank_mask:0xf
    v_fmac_f32_dpp v216, v224, v97 row_newbcast:1 row_mask:0xf bank_mask:0xf
    v_fmac_f32_dpp v216, v224, v98 row_newbcast:2 row_mask:0xf bank_mask:0xf
    v_fmac_f32_dpp v216, v224, v99 row_newbcast:3 row_mask:0xf bank_mask:0xf
    s_cmp_ge_u32 s3, 2
    s_cbranch_scc1 L_pxe
L_pollml:
    s_waitcnt vmcnt(0)
    v_perm_b32 v104, v246, v248, s35
    v_bitop3_b32 v109, v246, v247, v245 bitop3:0x7e
    v_and_b32 v105, s27, v247
    v_cndmask_b32 v104, v234, v104, s[98:99]
    v_cndmask_b32 v105, v235, v105, s[98:99]
    v_and_b32 v109, 0xff, v109
    v_max_f32_dpp v106, v104, v104 quad_perm:[1,0,3,2] row_mask:0xf bank_mask:0xf
    v_bitop3_b32 v109, v109, v248, v11 bitop3:0xf6
    v_and_b32 v109, 0xffffff, v109
    v_max_f32_dpp v106, v106, v106 quad_perm:[2,3,0,1] row_mask:0xf bank_mask:0xf
    v_cmp_ne_u32 vcc, 0, v109
    s_and_b64 vcc, vcc, s[74:75]
    s_cbranch_scc1 L_againml
L_gotml:
    v_max_f32_dpp v106, v106, v106 row_half_mirror row_mask:0xf bank_mask:0xf
    s_nop 1
    v_max_f32_dpp v106, v106, v106 row_mirror row_mask:0xf bank_mask:0xf
    v_sub_f32 v108, v104, v106
    v_exp_f32 v108, v108
    s_nop 0
    v_mul_f32 v107, v108, v105
    s_nop 1
    v_add_f32_dpp v107, v107, v107 quad_perm:[1,0,3,2] row_mask:0xf bank_mask:0xf
    s_nop 1
    v_add_f32_dpp v107, v107, v107 quad_perm:[2,3,0,1] row_mask:0xf bank_mask:0xf
    s_nop 1
    v_add_f32_dpp v107, v107, v107 row_half_mirror row_mask:0xf bank_mask:0xf
    s_nop 1
    v_add_f32_dpp v107, v107, v107 row_mirror row_mask:0xf bank_mask:0xf
    v_rcp_f32 v107, v107
    s_nop 0
    v_mul_f32 v108, v108, v107
    ds_write_b32 v62, v108
    s_cmp_lg_u32 s3, 0
    s_cbranch_scc1 L_pxe
    s_mov_b64 exec, 1
    buffer_store_dword v11, off, s[28:31], s24
    s_mov_b64 exec, -1
L_pxe:
    s_cmp_ge_u32 s3, 4
    s_cbranch_scc1 L_py
    s_lshr_b32 s58, s43, 27
    s_cmp_eq_u32 s58, 31
    s_cbranch_scc1 L_nowarmp
    s_mul_i32 s58, s58, 7168
    s_add_u32 s58, s58, s32
    v_lshlrev_b32 v24, 7, v1
    s_bfm_b64 exec, 56, 0
    buffer_load_dword v239, v24, s[28:31], s58 offen sc1
    s_mov_b64 exec, -1
L_nowarmp:
L_pb:
    s_cmp_lg_u32 s46, 1
    s_cbranch_scc1 L_pdone
    s_cmp_eq_u32 s47, 0
    s_waitcnt lgkmcnt(0)
    s_barrier
    s_cbranch_scc1 L_cissued
    buffer_load_dword v112, v56, s[28:31], s76 offen offset:0 sc1
    buffer_load_dword v113, v56, s[28:31], s76 offen offset:2048 sc1
    buffer_load_dword v114, v57, s[28:31], s76 offen offset:0 sc1
    buffer_load_dword v115, v57, s[28:31], s76 offen offset:2048 sc1
    buffer_load_dword v116, v58, s[28:31], s76 offen offset:0 sc1
    buffer_load_dword v117, v58, s[28:31], s76 offen offset:2048 sc1
    buffer_load_dword v118, v59, s[28:31], s76 offen offset:0 sc1
    s_cmp_le_u32 s47, 7
    s_cbranch_scc1 L_cissued
    buffer_load_dword v119, v59, s[28:31], s76 offen offset:2048 sc1
    s_cmp_le_u32 s47, 8
    s_cbranch_scc1 L_cissued
    buffer_load_dword v120, v60, s[28:31], s76 offen offset:0 sc1
L_cissued:
    ds_read2st64_b32 v[96:97], v31 offset0:0 offset1:65
    ds_read2st64_b32 v[98:99], v31 offset0:130 offset1:195
    ds_read_b32 v108, v62
    s_waitcnt lgkmcnt(0)
    v_fmac_f32_dpp v216, v224, v96 row_newbcast:4 row_mask:0xf bank_mask:0xf
    v_fmac_f32_dpp v216, v224, v97 row_newbcast:5 row_mask:0xf bank_mask:0xf
    v_fmac_f32_dpp v216, v224, v98 row_newbcast:6 row_mask:0xf bank_mask:0xf
    v_fmac_f32_dpp v216, v224, v99 row_newbcast:7 row_mask:0xf bank_mask:0xf
    v_mul_f32_dpp v216, v108, v216 row_newbcast:15 row_mask:0xf bank_mask:0xf
    s_waitcnt vmcnt(0)
    v_xor_b32 v133, v117, v245
    v_xor_b32 v134, v118, v245
    v_xor_b32 v135, v119, v245
    v_xor_b32 v136, v120, v245
    v_or3_b32 v110, v133, v134, v135
    v_or_b32 v110, v110, v136
    v_cmp_ne_u32_sdwa s[70:71], v110, 0 src0_sel:BYTE_0 src1_sel:DWORD
    v_xor_b32 v128, v112, v245
    v_xor_b32 v129, v113, v245
    v_xor_b32 v130, v114, v245
    v_xor_b32 v131, v115, v245
    v_xor_b32 v132, v116, v245
    v_or3_b32 v109, v128, v129, v130
    v_or3_b32 v109, v109, v131, v132
    v_cmp_ne_u32_sdwa vcc, v109, 0 src0_sel:BYTE_0 src1_sel:DWORD
L_both:
    s_or_b64 s[50:51], vcc, s[70:71]
    s_cbranch_scc1 L_bad
L_allok:
    v_mul_f32_dpp v100, v108, v128 row_newbcast:0 row_mask:0xf bank_mask:0xf
    v_fmac_f32_dpp v216, v108, v133 row_newbcast:5 row_mask:0xf bank_mask:0xf
    v_fmac_f32_dpp v100, v108, v129 row_newbcast:1 row_mask:0xf bank_mask:0xf
    v_fmac_f32_dpp v216, v108, v134 row_newbcast:6 row_mask:0xf bank_mask:0xf
    v_fmac_f32_dpp v100, v108, v130 row_newbcast:2 row_mask:0xf bank_mask:0xf
    v_fmac_f32_dpp v216, v108, v135 row_newbcast:7 row_mask:0xf bank_mask:0xf
    v_fmac_f32_dpp v100, v108, v131 row_newbcast:3 row_mask:0xf bank_mask:0xf
    v_fmac_f32_dpp v216, v108, v136 row_newbcast:8 row_mask:0xf bank_mask:0xf
    v_fmac_f32_dpp v100, v108, v132 row_newbcast:4 row_mask:0xf bank_mask:0xf
    v_add_f32 v100, v100, v216
    v_cvt_pk_bf16_f32 v100, v100, v100
    buffer_store_short v100, v10, s[20:23], s73 offen
    s_endpgm
L_bad:
    s_cbranch_vccnz L_sbad
    buffer_load_dword v117, v58, s[28:31], s76 offen offset:2048 sc1
    buffer_load_dword v118, v59, s[28:31], s76 offen offset:0 sc1
    s_cmp_le_u32 s47, 7
    s_cbranch_scc1 L_p1
    buffer_load_dword v119, v59, s[28:31], s76 offen offset:2048 sc1
    s_cmp_le_u32 s47, 8
    s_cbranch_scc1 L_p1
    buffer_load_dword v120, v60, s[28:31], s76 offen offset:0 sc1
L_p1:
    v_mul_f32_dpp v100, v108, v128 row_newbcast:0 row_mask:0xf bank_mask:0xf
    v_fmac_f32_dpp v100, v108, v129 row_newbcast:1 row_mask:0xf bank_mask:0xf
    v_fmac_f32_dpp v100, v108, v130 row_newbcast:2 row_mask:0xf bank_mask:0xf
    v_fmac_f32_dpp v100, v108, v131 row_newbcast:3 row_mask:0xf bank_mask:0xf
    v_fmac_f32_dpp v100, v108, v132 row_newbcast:4 row_mask:0xf bank_mask:0xf
    s_branch L_onlyp
L_rp:
    s_sub_u32 s59, s59, 1
    s_cmp_lt_i32 s59, 0
    s_cbranch_scc1 L_pok
    buffer_load_dword v117, v58, s[28:31], s76 offen offset:2048 sc1
    buffer_load_dword v118, v59, s[28:31], s76 offen offset:0 sc1
    s_cmp_le_u32 s47, 7
    s_cbranch_scc1 L_onlyp
    buffer_load_dword v119, v59, s[28:31], s76 offen offset:2048 sc1
    s_cmp_le_u32 s47, 8
    s_cbranch_scc1 L_onlyp
    buffer_load_dword v120, v60, s[28:31], s76 offen offset:0 sc1
L_onlyp:
    s_waitcnt vmcnt(0)
    v_xor_b32 v133, v117, v245
    v_xor_b32 v134, v118, v245
    v_xor_b32 v135, v119, v245
    v_xor_b32 v136, v120, v245
    v_or3_b32 v109, v133, v134, v135
    v_or_b32 v109, v109, v136
    v_cmp_ne_u32_sdwa vcc, v109, 0 src0_sel:BYTE_0 src1_sel:DWORD
    s_cbranch_vccnz L_rp
L_pok:
    v_fmac_f32_dpp v216, v108, v133 row_newbcast:5 row_mask:0xf bank_mask:0xf
    v_fmac_f32_dpp v216, v108, v134 row_newbcast:6 row_mask:0xf bank_mask:0xf
    v_fmac_f32_dpp v216, v108, v135 row_newbcast:7 row_mask:0xf bank_mask:0xf
    v_fmac_f32_dpp v216, v108, v136 row_newbcast:8 row_mask:0xf bank_mask:0xf
    v_add_f32 v100, v100, v216
    v_cvt_pk_bf16_f32 v100, v100, v100
    buffer_store_short v100, v10, s[20:23], s73 offen
    s_endpgm
L_sbad:
    buffer_load_dword v112, v56, s[28:31], s76 offen offset:0 sc1
    buffer_load_dword v113, v56, s[28:31], s76 offen offset:2048 sc1
    buffer_load_dword v114, v57, s[28:31], s76 offen offset:0 sc1
    buffer_load_dword v115, v57, s[28:31], s76 offen offset:2048 sc1
    buffer_load_dword v116, v58, s[28:31], s76 offen offset:0 sc1
    s_cmp_eq_u64 s[70:71], 0
    s_cbranch_scc1 L_s1
    buffer_load_dword v117, v58, s[28:31], s76 offen offset:2048 sc1
    buffer_load_dword v118, v59, s[28:31], s76 offen offset:0 sc1
    s_cmp_le_u32 s47, 7
    s_cbranch_scc1 L_b1
    buffer_load_dword v119, v59, s[28:31], s76 offen offset:2048 sc1
    s_cmp_le_u32 s47, 8
    s_cbranch_scc1 L_b1
    buffer_load_dword v120, v60, s[28:31], s76 offen offset:0 sc1
L_b1:
    s_sub_u32 s59, s59, 1
    s_cmp_lt_i32 s59, 0
    s_cbranch_scc1 L_allok
    s_waitcnt vmcnt(0)
    v_xor_b32 v133, v117, v245
    v_xor_b32 v134, v118, v245
    v_xor_b32 v135, v119, v245
    v_xor_b32 v136, v120, v245
    v_or3_b32 v110, v133, v134, v135
    v_or_b32 v110, v110, v136
    v_cmp_ne_u32_sdwa s[70:71], v110, 0 src0_sel:BYTE_0 src1_sel:DWORD
    v_xor_b32 v128, v112, v245
    v_xor_b32 v129, v113, v245
    v_xor_b32 v130, v114, v245
    v_xor_b32 v131, v115, v245
    v_xor_b32 v132, v116, v245
    v_or3_b32 v109, v128, v129, v130
    v_or3_b32 v109, v109, v131, v132
    v_cmp_ne_u32_sdwa vcc, v109, 0 src0_sel:BYTE_0 src1_sel:DWORD
    s_branch L_both
L_s1:
    v_fmac_f32_dpp v216, v108, v133 row_newbcast:5 row_mask:0xf bank_mask:0xf
    v_fmac_f32_dpp v216, v108, v134 row_newbcast:6 row_mask:0xf bank_mask:0xf
    v_fmac_f32_dpp v216, v108, v135 row_newbcast:7 row_mask:0xf bank_mask:0xf
    v_fmac_f32_dpp v216, v108, v136 row_newbcast:8 row_mask:0xf bank_mask:0xf
    s_branch L_onlys
L_rs:
    s_sub_u32 s59, s59, 1
    s_cmp_lt_i32 s59, 0
    s_cbranch_scc1 L_sok
    buffer_load_dword v112, v56, s[28:31], s76 offen offset:0 sc1
    buffer_load_dword v113, v56, s[28:31], s76 offen offset:2048 sc1
    buffer_load_dword v114, v57, s[28:31], s76 offen offset:0 sc1
    buffer_load_dword v115, v57, s[28:31], s76 offen offset:2048 sc1
    buffer_load_dword v116, v58, s[28:31], s76 offen offset:0 sc1
L_onlys:
    s_waitcnt vmcnt(0)
    v_xor_b32 v128, v112, v245
    v_xor_b32 v129, v113, v245
    v_xor_b32 v130, v114, v245
    v_xor_b32 v131, v115, v245
    v_xor_b32 v132, v116, v245
    v_or3_b32 v109, v128, v129, v130
    v_or3_b32 v109, v109, v131, v132
    v_cmp_ne_u32_sdwa vcc, v109, 0 src0_sel:BYTE_0 src1_sel:DWORD
    s_cbranch_vccnz L_rs
L_sok:
    v_mul_f32_dpp v100, v108, v128 row_newbcast:0 row_mask:0xf bank_mask:0xf
    v_fmac_f32_dpp v100, v108, v129 row_newbcast:1 row_mask:0xf bank_mask:0xf
    v_fmac_f32_dpp v100, v108, v130 row_newbcast:2 row_mask:0xf bank_mask:0xf
    v_fmac_f32_dpp v100, v108, v131 row_newbcast:3 row_mask:0xf bank_mask:0xf
    v_fmac_f32_dpp v100, v108, v132 row_newbcast:4 row_mask:0xf bank_mask:0xf
    v_add_f32 v100, v100, v216
    v_cvt_pk_bf16_f32 v100, v100, v100
    buffer_store_short v100, v10, s[20:23], s73 offen
    s_endpgm
L_pdone:
    s_waitcnt lgkmcnt(0)
    s_barrier
    s_endpgm
L_againml:
    s_sub_u32 s59, s59, 1
    s_cmp_lt_i32 s59, 0
    s_cbranch_scc1 L_gotml
    s_cmp_gt_u32 s59, 0xffff4
    s_cbranch_scc1 L_nearm
    s_xor_b32 s77, s77, s79
L_nearm:
    s_mov_b64 exec, vcc
    buffer_load_dwordx3 v[246:248], v61, s[28:31], s77 offen sc1
    s_mov_b64 exec, -1
    s_branch L_pollml
.p2align 12
L_shared:
    v_xor_b32 v24, v28, v2
    v_lshlrev_b32 v24, 4, v24
    v_lshl_add_u32 v24, v2, 9, v24
    v_add_u32 v24, 134656, v24
    v_xor_b32 v25, 0x80, v24
    v_xor_b32 v26, 16, v24
    v_xor_b32 v27, 0x90, v24
    ds_read_b128 v[32:35], v24 offset:0
    ds_read_b128 v[48:51], v26 offset:0
    ds_read_b128 v[36:39], v25 offset:0
    ds_read_b128 v[52:55], v27 offset:0
    ds_read_b128 v[40:43], v24 offset:256
    ds_read_b128 v[56:59], v26 offset:256
    ds_read_b128 v[44:47], v25 offset:256
    ds_read_b128 v[60:63], v27 offset:256
    s_waitcnt vmcnt(8) lgkmcnt(0)
    v_mfma_f32_16x16x32_bf16 v[192:195], v[64:67], v[32:35], 0
    v_mfma_f32_16x16x32_bf16 v[196:199], v[64:67], v[48:51], 0
    v_mfma_f32_16x16x32_bf16 v[200:203], v[80:83], v[32:35], 0
    v_mfma_f32_16x16x32_bf16 v[204:207], v[80:83], v[48:51], 0
    v_mfma_f32_16x16x32_bf16 v[192:195], v[68:71], v[36:39], v[192:195]
    v_mfma_f32_16x16x32_bf16 v[196:199], v[68:71], v[52:55], v[196:199]
    v_mfma_f32_16x16x32_bf16 v[200:203], v[84:87], v[36:39], v[200:203]
    v_mfma_f32_16x16x32_bf16 v[204:207], v[84:87], v[52:55], v[204:207]
    v_mfma_f32_16x16x32_bf16 v[192:195], v[72:75], v[40:43], v[192:195]
    v_mfma_f32_16x16x32_bf16 v[196:199], v[72:75], v[56:59], v[196:199]
    v_mfma_f32_16x16x32_bf16 v[200:203], v[88:91], v[40:43], v[200:203]
    v_mfma_f32_16x16x32_bf16 v[204:207], v[88:91], v[56:59], v[204:207]
    v_mfma_f32_16x16x32_bf16 v[192:195], v[76:79], v[44:47], v[192:195]
    v_mfma_f32_16x16x32_bf16 v[196:199], v[76:79], v[60:63], v[196:199]
    v_mfma_f32_16x16x32_bf16 v[200:203], v[92:95], v[44:47], v[200:203]
    v_mfma_f32_16x16x32_bf16 v[204:207], v[92:95], v[60:63], v[204:207]
    s_waitcnt vmcnt(0)
    v_mfma_f32_16x16x32_bf16 v[208:211], v[96:99], v[32:35], 0
    v_mfma_f32_16x16x32_bf16 v[212:215], v[96:99], v[48:51], 0
    v_mfma_f32_16x16x32_bf16 v[216:219], v[112:115], v[32:35], 0
    v_mfma_f32_16x16x32_bf16 v[220:223], v[112:115], v[48:51], 0
    v_mfma_f32_16x16x32_bf16 v[208:211], v[100:103], v[36:39], v[208:211]
    v_mfma_f32_16x16x32_bf16 v[212:215], v[100:103], v[52:55], v[212:215]
    v_mfma_f32_16x16x32_bf16 v[216:219], v[116:119], v[36:39], v[216:219]
    v_mfma_f32_16x16x32_bf16 v[220:223], v[116:119], v[52:55], v[220:223]
    v_mfma_f32_16x16x32_bf16 v[208:211], v[104:107], v[40:43], v[208:211]
    v_mfma_f32_16x16x32_bf16 v[212:215], v[104:107], v[56:59], v[212:215]
    v_mfma_f32_16x16x32_bf16 v[216:219], v[120:123], v[40:43], v[216:219]
    v_mfma_f32_16x16x32_bf16 v[220:223], v[120:123], v[56:59], v[220:223]
    v_mfma_f32_16x16x32_bf16 v[208:211], v[108:111], v[44:47], v[208:211]
    v_mfma_f32_16x16x32_bf16 v[212:215], v[108:111], v[60:63], v[212:215]
    v_mfma_f32_16x16x32_bf16 v[216:219], v[124:127], v[44:47], v[216:219]
    v_mfma_f32_16x16x32_bf16 v[220:223], v[124:127], v[60:63], v[220:223]
    s_nop 3
    v_add_f32 v224, v192, v197
    v_add_f32 v225, v194, v199
    v_add_f32 v226, v200, v205
    v_add_f32 v227, v202, v207
    v_add_f32 v228, v208, v213
    v_add_f32 v229, v210, v215
    v_add_f32 v230, v216, v221
    v_add_f32 v231, v218, v223
    s_cmp_lt_u32 s3, 4
    s_cbranch_scc1 L_sh0
    s_load_dword s34, s[28:29], s24 offset:128
L_sh0:
    v_cndmask_b32 v228, v244, v228, s[50:51]
    v_cndmask_b32 v229, v244, v229, s[52:53]
    v_cndmask_b32 v230, v244, v230, s[54:55]
    v_cndmask_b32 v231, v244, v231, s[56:57]
    v_max3_f32 v232, v224, v225, v226
    v_max3_f32 v235, v227, v228, v229
    v_max3_f32 v232, v232, v230, v231
    v_max_f32 v232, v232, v235
    v_mov_b32 v234, v232
    s_nop 1
    v_permlane16_swap_b32 v232, v234
    v_max_f32 v232, v232, v234
    v_mov_b32 v234, v232
    s_nop 1
    v_permlane32_swap_b32 v232, v234
    v_max_f32 v232, v232, v234
    v_mul_f32 v232, s49, v232
    v_fma_f32 v224, v224, s49, -v232
    v_fma_f32 v225, v225, s49, -v232
    v_fma_f32 v226, v226, s49, -v232
    v_fma_f32 v227, v227, s49, -v232
    v_fma_f32 v228, v228, s49, -v232
    v_fma_f32 v229, v229, s49, -v232
    v_fma_f32 v230, v230, s49, -v232
    v_fma_f32 v231, v231, s49, -v232
    v_exp_f32 v224, v224
    v_exp_f32 v225, v225
    v_exp_f32 v226, v226
    v_exp_f32 v227, v227
    v_exp_f32 v228, v228
    v_exp_f32 v229, v229
    v_exp_f32 v230, v230
    v_exp_f32 v231, v231
    v_add_f32 v233, v224, v225
    v_add_f32 v235, v226, v227
    v_add_f32 v233, v233, v228
    v_add_f32 v235, v235, v229
    v_add_f32 v233, v233, v230
    v_add_f32 v235, v235, v231
    v_add_f32 v233, v233, v235
    v_mov_b32 v234, v233
    s_nop 1
    v_permlane16_swap_b32 v233, v234
    v_add_f32 v233, v233, v234
    v_mov_b32 v234, v233
    s_nop 1
    v_permlane32_swap_b32 v233, v234
    v_add_f32 v233, v233, v234
    v_lshlrev_b32 v24, 6, v2
    s_lshl_b32 s58, s3, 3
    s_add_u32 s58, s58, 133120
    v_add_u32 v24, s58, v24
    ds_write_b64 v24, v[232:233]
    v_cvt_pk_bf16_f32 v240, v224, v225
    v_cvt_pk_bf16_f32 v241, v226, v227
    v_cvt_pk_bf16_f32 v242, v228, v229
    v_cvt_pk_bf16_f32 v243, v230, v231
    s_lshl4_add_u32 s77, s47, s33
    v_and_b32 v25, 7, v1
    v_lshlrev_b32 v10, 3, v1
    v_lshrrev_b32 v20, 5, v1
    s_lshl_b32 s58, s3, 7
    s_add_u32 s58, s58, 133120
    v_lshl_or_b32 v29, v20, 3, v25
    v_lshl_add_u32 v29, v29, 3, s58
    s_mov_b32 s66, 1
    s_mov_b32 s67, 1
    s_waitcnt lgkmcnt(0)
    s_barrier
    s_cmp_ge_u32 s3, 4
    s_cbranch_scc1 L_sw
L_sv:
    buffer_load_dwordx4 v[128:131], v6, s[8:11], s40 offen offset:0 nt
    buffer_load_dwordx4 v[136:139], v7, s[8:11], s40 offen offset:0 nt
    buffer_load_dwordx4 v[144:147], v8, s[8:11], s40 offen offset:0 nt
    buffer_load_dwordx4 v[152:155], v9, s[8:11], s40 offen offset:0 nt
    buffer_load_dwordx4 v[160:163], v12, s[8:11], s62 offen offset:0 nt
    buffer_load_dwordx4 v[168:171], v13, s[8:11], s62 offen offset:0 nt
    buffer_load_dwordx4 v[176:179], v14, s[8:11], s62 offen offset:0 nt
    buffer_load_dwordx4 v[184:187], v15, s[8:11], s62 offen offset:0 nt
    s_mov_b32 s64, 0x05040100
    s_mov_b32 s65, 0x07060302
    v_mul_u32_u24 v16, 1040, v2
    v_lshl_add_u32 v16, v3, 7, v16
    s_mul_i32 s58, s3, 16640
    v_add_u32 v16, s58, v16
    v_and_b32 v21, 31, v1
    v_lshlrev_b32 v21, 4, v21
    v_lshl_or_b32 v17, v20, 10, v21
    v_mul_u32_u24 v20, 1040, v20
    s_mul_i32 s58, s3, 2080
    v_add3_u32 v30, v20, v21, s58
    v_add_u32 v31, 66560, v30
    buffer_load_dwordx4 v[132:135], v6, s[8:11], s40 offen offset:256 nt
    buffer_load_dwordx4 v[140:143], v7, s[8:11], s40 offen offset:256 nt
    buffer_load_dwordx4 v[148:151], v8, s[8:11], s40 offen offset:256 nt
    buffer_load_dwordx4 v[156:159], v9, s[8:11], s40 offen offset:256 nt
    buffer_load_dwordx4 v[164:167], v12, s[8:11], s62 offen offset:256 nt
    buffer_load_dwordx4 v[172:175], v13, s[8:11], s62 offen offset:256 nt
    buffer_load_dwordx4 v[180:183], v14, s[8:11], s62 offen offset:256 nt
    buffer_load_dwordx4 v[188:191], v15, s[8:11], s62 offen offset:256 nt
    s_cmp_ge_u32 s3, 4
    s_cbranch_scc1 L_sx
    s_barrier
    s_load_dword s34, s[28:29], s24 offset:128
L_sw:
    ds_read_b64 v[232:233], v29
    s_waitcnt lgkmcnt(0)
    v_max_f32_dpp v234, v232, v232 quad_perm:[1,0,3,2] row_mask:0xf bank_mask:0xf
    s_nop 1
    v_max_f32_dpp v234, v234, v234 quad_perm:[2,3,0,1] row_mask:0xf bank_mask:0xf
    s_nop 1
    v_max_f32_dpp v234, v234, v234 row_half_mirror row_mask:0xf bank_mask:0xf
    v_sub_f32 v224, v232, v234
    v_exp_f32 v224, v224
    s_nop 0
    v_mul_f32 v235, v224, v233
    s_nop 1
    v_add_f32_dpp v235, v235, v235 quad_perm:[1,0,3,2] row_mask:0xf bank_mask:0xf
    s_nop 1
    v_add_f32_dpp v235, v235, v235 quad_perm:[2,3,0,1] row_mask:0xf bank_mask:0xf
    s_nop 1
    v_add_f32_dpp v235, v235, v235 row_half_mirror row_mask:0xf bank_mask:0xf
    s_mov_b32 s58, 0x04020100
    v_perm_b32 v236, v234, v11, s58
    v_and_or_b32 v234, v234, s27, v245
    v_and_or_b32 v235, v235, s27, v245
    s_cmp_lt_u32 s3, 4
    s_cbranch_scc1 L_sy0
    s_mov_b64 exec, s[66:67]
    s_cmp_lg_u32 s34, s26
    s_cbranch_scc1 L_mfs
L_mns:
    buffer_store_dwordx3 v[234:236], v10, s[28:31], s77 offen
L_mds:
    s_mov_b64 exec, -1
    s_branch L_sv
L_sy0:
    s_waitcnt vmcnt(14)
    v_perm_b32 v64, v136, v128, s64
    v_perm_b32 v68, v136, v128, s65
    v_perm_b32 v72, v137, v129, s64
    v_perm_b32 v76, v137, v129, s65
    v_perm_b32 v80, v138, v130, s64
    v_perm_b32 v84, v138, v130, s65
    v_perm_b32 v88, v139, v131, s64
    v_perm_b32 v92, v139, v131, s65
    s_waitcnt vmcnt(12)
    v_perm_b32 v65, v152, v144, s64
    v_perm_b32 v69, v152, v144, s65
    v_perm_b32 v73, v153, v145, s64
    v_perm_b32 v77, v153, v145, s65
    v_perm_b32 v81, v154, v146, s64
    v_perm_b32 v85, v154, v146, s65
    v_perm_b32 v89, v155, v147, s64
    v_perm_b32 v93, v155, v147, s65
    s_waitcnt vmcnt(10)
    v_perm_b32 v66, v168, v160, s64
    v_perm_b32 v70, v168, v160, s65
    v_perm_b32 v74, v169, v161, s64
    v_perm_b32 v78, v169, v161, s65
    v_perm_b32 v82, v170, v162, s64
    v_perm_b32 v86, v170, v162, s65
    v_perm_b32 v90, v171, v163, s64
    v_perm_b32 v94, v171, v163, s65
    s_waitcnt vmcnt(8)
    v_perm_b32 v67, v184, v176, s64
    v_perm_b32 v71, v184, v176, s65
    v_perm_b32 v75, v185, v177, s64
    v_mfma_f32_16x16x32_bf16 v[32:35], v[64:67], v[240:243], 0
    v_perm_b32 v79, v185, v177, s65
    v_mfma_f32_16x16x32_bf16 v[36:39], v[68:71], v[240:243], 0
    v_perm_b32 v83, v186, v178, s64
    v_mfma_f32_16x16x32_bf16 v[40:43], v[72:75], v[240:243], 0
    v_perm_b32 v87, v186, v178, s65
    v_mfma_f32_16x16x32_bf16 v[44:47], v[76:79], v[240:243], 0
    v_perm_b32 v91, v187, v179, s64
    v_mfma_f32_16x16x32_bf16 v[48:51], v[80:83], v[240:243], 0
    v_perm_b32 v95, v187, v179, s65
    v_mfma_f32_16x16x32_bf16 v[52:55], v[84:87], v[240:243], 0
    s_nop 0
    v_mfma_f32_16x16x32_bf16 v[56:59], v[88:91], v[240:243], 0
    ds_write_b128 v16, v[32:35] offset:0
    v_mfma_f32_16x16x32_bf16 v[60:63], v[92:95], v[240:243], 0
    ds_write_b128 v16, v[36:39] offset:16
    ds_write_b128 v16, v[40:43] offset:32
    s_nop 0
    ds_write_b128 v16, v[44:47] offset:48
    s_nop 0
    ds_write_b128 v16, v[48:51] offset:64
    s_nop 0
    ds_write_b128 v16, v[52:55] offset:80
    ds_write_b128 v16, v[56:59] offset:96
    ds_write_b128 v16, v[60:63] offset:112
    s_cmp_ge_u32 s3, 4
    s_cbranch_scc1 L_sh
L_sy1:
    s_waitcnt vmcnt(6)
    v_perm_b32 v96, v140, v132, s64
    v_perm_b32 v100, v140, v132, s65
    v_perm_b32 v104, v141, v133, s64
    v_perm_b32 v108, v141, v133, s65
    v_perm_b32 v112, v142, v134, s64
    v_perm_b32 v116, v142, v134, s65
    v_perm_b32 v120, v143, v135, s64
    v_perm_b32 v124, v143, v135, s65
    s_waitcnt vmcnt(4)
    v_perm_b32 v97, v156, v148, s64
    v_perm_b32 v101, v156, v148, s65
    v_perm_b32 v105, v157, v149, s64
    v_perm_b32 v109, v157, v149, s65
    v_perm_b32 v113, v158, v150, s64
    v_perm_b32 v117, v158, v150, s65
    v_perm_b32 v121, v159, v151, s64
    v_perm_b32 v125, v159, v151, s65
    s_waitcnt vmcnt(2)
    v_perm_b32 v98, v172, v164, s64
    v_perm_b32 v102, v172, v164, s65
    v_perm_b32 v106, v173, v165, s64
    v_perm_b32 v110, v173, v165, s65
    v_perm_b32 v114, v174, v166, s64
    v_perm_b32 v118, v174, v166, s65
    v_perm_b32 v122, v175, v167, s64
    v_perm_b32 v126, v175, v167, s65
    s_waitcnt vmcnt(0)
    v_perm_b32 v99, v188, v180, s64
    v_perm_b32 v103, v188, v180, s65
    v_perm_b32 v107, v189, v181, s64
    v_mfma_f32_16x16x32_bf16 v[192:195], v[96:99], v[240:243], 0
    v_perm_b32 v111, v189, v181, s65
    v_mfma_f32_16x16x32_bf16 v[196:199], v[100:103], v[240:243], 0
    v_perm_b32 v115, v190, v182, s64
    v_mfma_f32_16x16x32_bf16 v[200:203], v[104:107], v[240:243], 0
    v_perm_b32 v119, v190, v182, s65
    v_mfma_f32_16x16x32_bf16 v[204:207], v[108:111], v[240:243], 0
    v_perm_b32 v123, v191, v183, s64
    v_mfma_f32_16x16x32_bf16 v[208:211], v[112:115], v[240:243], 0
    v_perm_b32 v127, v191, v183, s65
    v_mfma_f32_16x16x32_bf16 v[212:215], v[116:119], v[240:243], 0
    s_nop 0
    v_mfma_f32_16x16x32_bf16 v[216:219], v[120:123], v[240:243], 0
    ds_write_b128 v16, v[192:195] offset:512
    v_mfma_f32_16x16x32_bf16 v[220:223], v[124:127], v[240:243], 0
    ds_write_b128 v16, v[196:199] offset:528
    ds_write_b128 v16, v[200:203] offset:544
    s_nop 0
    ds_write_b128 v16, v[204:207] offset:560
    s_nop 0
    ds_write_b128 v16, v[208:211] offset:576
    s_nop 0
    ds_write_b128 v16, v[212:215] offset:592
    ds_write_b128 v16, v[216:219] offset:608
    ds_write_b128 v16, v[220:223] offset:624
    s_cmp_ge_u32 s3, 4
    s_cbranch_scc1 L_sb
    s_mov_b64 exec, s[66:67]
    s_cmp_lg_u32 s34, s26
    s_cbranch_scc1 L_mft
L_mnt:
    buffer_store_dwordx3 v[234:236], v10, s[28:31], s77 offen
L_mdt:
    s_mov_b64 exec, -1
L_sx:
    s_waitcnt lgkmcnt(0)
    s_barrier
    ds_read_b128 v[32:35], v30 offset:0
    ds_read_b128 v[48:51], v30 offset:512
    ds_read_b128 v[36:39], v30 offset:16640
    ds_read_b128 v[52:55], v30 offset:17152
    ds_read_b128 v[40:43], v30 offset:33280
    ds_read_b128 v[56:59], v30 offset:33792
    ds_read_b128 v[44:47], v30 offset:49920
    ds_read_b128 v[60:63], v30 offset:50432
    s_waitcnt lgkmcnt(6)
    v_mul_f32_dpp v248, v224, v32 row_newbcast:0 row_mask:0xf bank_mask:0xf
    v_mul_f32_dpp v249, v224, v33 row_newbcast:0 row_mask:0xf bank_mask:0xf
    v_mul_f32_dpp v250, v224, v34 row_newbcast:0 row_mask:0xf bank_mask:0xf
    v_mul_f32_dpp v251, v224, v35 row_newbcast:0 row_mask:0xf bank_mask:0xf
    v_mul_f32_dpp v252, v224, v48 row_newbcast:0 row_mask:0xf bank_mask:0xf
    v_mul_f32_dpp v253, v224, v49 row_newbcast:0 row_mask:0xf bank_mask:0xf
    v_mul_f32_dpp v254, v224, v50 row_newbcast:0 row_mask:0xf bank_mask:0xf
    v_mul_f32_dpp v255, v224, v51 row_newbcast:0 row_mask:0xf bank_mask:0xf
    s_waitcnt lgkmcnt(4)
    v_fmac_f32_dpp v248, v224, v36 row_newbcast:1 row_mask:0xf bank_mask:0xf
    v_fmac_f32_dpp v249, v224, v37 row_newbcast:1 row_mask:0xf bank_mask:0xf
    v_fmac_f32_dpp v250, v224, v38 row_newbcast:1 row_mask:0xf bank_mask:0xf
    v_fmac_f32_dpp v251, v224, v39 row_newbcast:1 row_mask:0xf bank_mask:0xf
    v_fmac_f32_dpp v252, v224, v52 row_newbcast:1 row_mask:0xf bank_mask:0xf
    v_fmac_f32_dpp v253, v224, v53 row_newbcast:1 row_mask:0xf bank_mask:0xf
    v_fmac_f32_dpp v254, v224, v54 row_newbcast:1 row_mask:0xf bank_mask:0xf
    v_fmac_f32_dpp v255, v224, v55 row_newbcast:1 row_mask:0xf bank_mask:0xf
    s_waitcnt lgkmcnt(2)
    v_fmac_f32_dpp v248, v224, v40 row_newbcast:2 row_mask:0xf bank_mask:0xf
    v_fmac_f32_dpp v249, v224, v41 row_newbcast:2 row_mask:0xf bank_mask:0xf
    v_fmac_f32_dpp v250, v224, v42 row_newbcast:2 row_mask:0xf bank_mask:0xf
    v_fmac_f32_dpp v251, v224, v43 row_newbcast:2 row_mask:0xf bank_mask:0xf
    v_fmac_f32_dpp v252, v224, v56 row_newbcast:2 row_mask:0xf bank_mask:0xf
    v_fmac_f32_dpp v253, v224, v57 row_newbcast:2 row_mask:0xf bank_mask:0xf
    v_fmac_f32_dpp v254, v224, v58 row_newbcast:2 row_mask:0xf bank_mask:0xf
    v_fmac_f32_dpp v255, v224, v59 row_newbcast:2 row_mask:0xf bank_mask:0xf
    s_waitcnt lgkmcnt(0)
    v_fmac_f32_dpp v248, v224, v44 row_newbcast:3 row_mask:0xf bank_mask:0xf
    v_fmac_f32_dpp v249, v224, v45 row_newbcast:3 row_mask:0xf bank_mask:0xf
    v_fmac_f32_dpp v250, v224, v46 row_newbcast:3 row_mask:0xf bank_mask:0xf
    v_fmac_f32_dpp v251, v224, v47 row_newbcast:3 row_mask:0xf bank_mask:0xf
    v_fmac_f32_dpp v252, v224, v60 row_newbcast:3 row_mask:0xf bank_mask:0xf
    v_fmac_f32_dpp v253, v224, v61 row_newbcast:3 row_mask:0xf bank_mask:0xf
    v_fmac_f32_dpp v254, v224, v62 row_newbcast:3 row_mask:0xf bank_mask:0xf
    v_fmac_f32_dpp v255, v224, v63 row_newbcast:3 row_mask:0xf bank_mask:0xf
    s_cmp_ge_u32 s3, 4
    s_cbranch_scc1 L_sy0
L_sh:
    s_waitcnt lgkmcnt(0)
    s_barrier
    ds_read_b128 v[32:35], v31 offset:0
    ds_read_b128 v[36:39], v31 offset:16640
    ds_read_b128 v[40:43], v31 offset:33280
    ds_read_b128 v[44:47], v31 offset:49920
    s_waitcnt lgkmcnt(3)
    v_fmac_f32_dpp v248, v224, v32 row_newbcast:4 row_mask:0xf bank_mask:0xf
    v_fmac_f32_dpp v249, v224, v33 row_newbcast:4 row_mask:0xf bank_mask:0xf
    v_fmac_f32_dpp v250, v224, v34 row_newbcast:4 row_mask:0xf bank_mask:0xf
    v_fmac_f32_dpp v251, v224, v35 row_newbcast:4 row_mask:0xf bank_mask:0xf
    s_waitcnt lgkmcnt(2)
    v_fmac_f32_dpp v248, v224, v36 row_newbcast:5 row_mask:0xf bank_mask:0xf
    v_fmac_f32_dpp v249, v224, v37 row_newbcast:5 row_mask:0xf bank_mask:0xf
    v_fmac_f32_dpp v250, v224, v38 row_newbcast:5 row_mask:0xf bank_mask:0xf
    v_fmac_f32_dpp v251, v224, v39 row_newbcast:5 row_mask:0xf bank_mask:0xf
    s_waitcnt lgkmcnt(1)
    v_fmac_f32_dpp v248, v224, v40 row_newbcast:6 row_mask:0xf bank_mask:0xf
    v_fmac_f32_dpp v249, v224, v41 row_newbcast:6 row_mask:0xf bank_mask:0xf
    v_fmac_f32_dpp v250, v224, v42 row_newbcast:6 row_mask:0xf bank_mask:0xf
    v_fmac_f32_dpp v251, v224, v43 row_newbcast:6 row_mask:0xf bank_mask:0xf
    s_waitcnt lgkmcnt(0)
    v_fmac_f32_dpp v248, v224, v44 row_newbcast:7 row_mask:0xf bank_mask:0xf
    v_fmac_f32_dpp v249, v224, v45 row_newbcast:7 row_mask:0xf bank_mask:0xf
    v_fmac_f32_dpp v250, v224, v46 row_newbcast:7 row_mask:0xf bank_mask:0xf
    v_fmac_f32_dpp v251, v224, v47 row_newbcast:7 row_mask:0xf bank_mask:0xf
    v_and_or_b32 v248, v248, s27, v245
    v_and_or_b32 v249, v249, s27, v245
    v_and_or_b32 v250, v250, s27, v245
    v_and_or_b32 v251, v251, s27, v245
    s_cmp_ge_u32 s3, 4
    s_cbranch_scc1 L_sy1
L_sb:
    s_cmp_lg_u32 s34, s26
    s_cbranch_scc1 L_wts0
    buffer_store_dwordx4 v[248:251], v17, s[28:31], s61 offen offset:0
L_puts0:
    s_waitcnt lgkmcnt(0)
    s_barrier
    ds_read_b128 v[48:51], v31 offset:512
    ds_read_b128 v[52:55], v31 offset:17152
    ds_read_b128 v[56:59], v31 offset:33792
    ds_read_b128 v[60:63], v31 offset:50432
    s_waitcnt lgkmcnt(3)
    v_fmac_f32_dpp v252, v224, v48 row_newbcast:4 row_mask:0xf bank_mask:0xf
    v_fmac_f32_dpp v253, v224, v49 row_newbcast:4 row_mask:0xf bank_mask:0xf
    v_fmac_f32_dpp v254, v224, v50 row_newbcast:4 row_mask:0xf bank_mask:0xf
    v_fmac_f32_dpp v255, v224, v51 row_newbcast:4 row_mask:0xf bank_mask:0xf
    s_waitcnt lgkmcnt(2)
    v_fmac_f32_dpp v252, v224, v52 row_newbcast:5 row_mask:0xf bank_mask:0xf
    v_fmac_f32_dpp v253, v224, v53 row_newbcast:5 row_mask:0xf bank_mask:0xf
    v_fmac_f32_dpp v254, v224, v54 row_newbcast:5 row_mask:0xf bank_mask:0xf
    v_fmac_f32_dpp v255, v224, v55 row_newbcast:5 row_mask:0xf bank_mask:0xf
    s_waitcnt lgkmcnt(1)
    v_fmac_f32_dpp v252, v224, v56 row_newbcast:6 row_mask:0xf bank_mask:0xf
    v_fmac_f32_dpp v253, v224, v57 row_newbcast:6 row_mask:0xf bank_mask:0xf
    v_fmac_f32_dpp v254, v224, v58 row_newbcast:6 row_mask:0xf bank_mask:0xf
    v_fmac_f32_dpp v255, v224, v59 row_newbcast:6 row_mask:0xf bank_mask:0xf
    s_waitcnt lgkmcnt(0)
    v_fmac_f32_dpp v252, v224, v60 row_newbcast:7 row_mask:0xf bank_mask:0xf
    v_fmac_f32_dpp v253, v224, v61 row_newbcast:7 row_mask:0xf bank_mask:0xf
    v_fmac_f32_dpp v254, v224, v62 row_newbcast:7 row_mask:0xf bank_mask:0xf
    v_fmac_f32_dpp v255, v224, v63 row_newbcast:7 row_mask:0xf bank_mask:0xf
    v_and_or_b32 v252, v252, s27, v245
    v_and_or_b32 v253, v253, s27, v245
    v_and_or_b32 v254, v254, s27, v245
    v_and_or_b32 v255, v255, s27, v245
    s_cbranch_scc1 L_wts1
    buffer_store_dwordx4 v[252:255], v17, s[28:31], s61 offen offset:512
L_puts1:
L_fin:
L_end:
    s_endpgm
L_mfa:
    s_load_dword s34, s[28:29], s24 offset:128 glc
    s_waitcnt lgkmcnt(0)
    s_cmp_eq_u32 s34, s26
    s_cbranch_scc1 L_mna
    s_add_u32 s58, s77, 1196032
    buffer_store_dwordx3 v[234:236], v10, s[28:31], s58 offen sc1
    s_branch L_mda
L_wta0:
    buffer_store_dwordx4 v[216:219], v17, s[28:31], s61 offen offset:0 sc1
    s_branch L_puta0
L_wta1:
    buffer_store_dwordx4 v[220:223], v17, s[28:31], s61 offen offset:512 sc1
    s_branch L_puta1
L_mfl:
    s_load_dword s34, s[28:29], s24 offset:128 glc
    s_waitcnt lgkmcnt(0)
    s_cmp_eq_u32 s34, s26
    s_cbranch_scc1 L_mnl
    s_add_u32 s58, s77, 1196032
    buffer_store_dwordx3 v[234:236], v10, s[28:31], s58 offen sc1
    s_branch L_mdl
L_wtl0:
    buffer_store_dwordx4 v[216:219], v17, s[28:31], s61 offen offset:0 sc1
    s_branch L_putl0
L_wtl1:
    buffer_store_dwordx4 v[220:223], v17, s[28:31], s61 offen offset:512 sc1
    s_branch L_putl1
L_mfs:
    s_load_dword s34, s[28:29], s24 offset:128 glc
    s_waitcnt lgkmcnt(0)
    s_cmp_eq_u32 s34, s26
    s_cbranch_scc1 L_mns
    s_add_u32 s58, s77, 1196032
    buffer_store_dwordx3 v[234:236], v10, s[28:31], s58 offen sc1
    s_branch L_mds
L_mft:
    s_load_dword s34, s[28:29], s24 offset:128 glc
    s_waitcnt lgkmcnt(0)
    s_cmp_eq_u32 s34, s26
    s_cbranch_scc1 L_mnt
    s_add_u32 s58, s77, 1196032
    buffer_store_dwordx3 v[234:236], v10, s[28:31], s58 offen sc1
    s_branch L_mdt
L_wts0:
    buffer_store_dwordx4 v[248:251], v17, s[28:31], s61 offen offset:0 sc1
    s_branch L_puts0
L_wts1:
    buffer_store_dwordx4 v[252:255], v17, s[28:31], s61 offen offset:512 sc1
    s_branch L_puts1
L_wait:
    v_mov_b32 v29, 134208
    v_mov_b32 v30, 0
    v_mov_b32 v31, 0
    ds_write_b64 v29, v[30:31]
    s_lshr_b32 s58, s2, 3
    s_cmp_eq_u32 s3, 4
    s_cselect_b32 s59, 0x44488920, 0
    s_bitcmp1_b32 s59, s58
    s_cbranch_scc1 L_hello
    s_load_dwordx2 s[42:43], s[38:39], s71
    s_waitcnt lgkmcnt(0)
    s_barrier
    s_branch L_go
L_hello:
    s_setprio 3
    s_load_dwordx2 s[32:33], s[0:1], 56
    s_mov_b32 s34, 1196032
    s_mov_b32 s35, 0x20000
    s_bfm_b32 s58, s58, 0
    s_and_b32 s58, s58, s59
    s_bcnt1_i32_b32 s58, s58
    s_lshl3_add_u32 s58, s44, s58
    s_lshl_b32 s58, s58, 8
    s_add_u32 s58, s58, 1179648
    s_getreg_b32 s26, hwreg(HW_REG_XCC_ID, 0, 4)
    s_lshl_b32 s26, s26, 28
    s_waitcnt lgkmcnt(0)
    s_load_dword s25, s[32:33], s58
    s_load_dwordx2 s[42:43], s[38:39], s71
    s_waitcnt lgkmcnt(0)
    s_add_u32 s25, s25, 1
    s_xor_b32 s26, s26, s25
    v_mov_b32 v29, s26
    s_add_u32 s58, s58, 128
    s_mov_b64 exec, 1
    buffer_store_dword v29, off, s[32:35], s58
    buffer_load_dword v239, off, s[32:35], s58 sc1
    s_mov_b64 exec, -1
    s_setprio 0
    s_barrier
    s_branch L_go
L_mismatch:
    s_waitcnt vmcnt(0) lgkmcnt(0)
    s_barrier
    s_mov_b64 s[98:99], 0
    s_mov_b32 s47, 0
    s_mov_b32 s72, 0
    s_mov_b32 s41, -1
    s_lshl_b32 s58, s45, 2
    s_load_dword s48, s[36:37], s58
    v_lshlrev_b32 v12, 1, v3
    v_add_u32 v13, 1, v12
    v_add_u32 v14, 8, v12
    v_add_u32 v15, 9, v12
    v_mov_b32 v237, v244
    v_mov_b32 v233, 0
    v_mov_b32 v208, 0
    v_mov_b32 v209, 0
    v_mov_b32 v210, 0
    v_mov_b32 v211, 0
    v_mov_b32 v212, 0
    v_mov_b32 v213, 0
    v_mov_b32 v214, 0
    v_mov_b32 v215, 0
    s_mov_b32 s92, s3
    s_waitcnt lgkmcnt(0)
    s_min_i32 s48, s48, 0x800
    s_cmp_gt_i32 s48, 0
    s_cselect_b32 s93, s48, 0x800
    s_max_i32 s48, s48, 0
L_gloop:
    s_lshl_b32 s94, s92, 4
    s_cmp_ge_u32 s94, s93
    s_cbranch_scc1 L_gdone
    s_lshl_b32 s58, s45, 7
    s_add_u32 s58, s58, s92
    s_lshl_b32 s58, s58, 2
    s_load_dword s95, s[16:17], s58
    s_sub_i32 s94, s48, s94
    v_cmp_gt_i32 s[50:51], s94, v12
    v_cmp_gt_i32 s[52:53], s94, v13
    v_cmp_gt_i32 s[54:55], s94, v14
    v_cmp_gt_i32 s[56:57], s94, v15
    s_waitcnt lgkmcnt(0)
    s_cmp_lt_i32 s95, 0
    s_cselect_b32 s58, 576, 0
    s_add_u32 s95, s95, s58
    s_min_u32 s95, s95, 575
    s_lshl_b32 s95, s95, 16
    s_add_u32 s40, s95, s60
    buffer_load_dwordx4 v[96:99], v4, s[4:7], s40 offen offset:0
    buffer_load_dwordx4 v[100:103], v4, s[4:7], s40 offen offset:128
    buffer_load_dwordx4 v[104:107], v4, s[4:7], s40 offen offset:256
    buffer_load_dwordx4 v[108:111], v4, s[4:7], s40 offen offset:384
    buffer_load_dwordx4 v[112:115], v5, s[4:7], s40 offen offset:0
    buffer_load_dwordx4 v[116:119], v5, s[4:7], s40 offen offset:128
    buffer_load_dwordx4 v[120:123], v5, s[4:7], s40 offen offset:256
    buffer_load_dwordx4 v[124:127], v5, s[4:7], s40 offen offset:384
    buffer_load_dwordx4 v[128:131], v6, s[8:11], s40 offen offset:0
    buffer_load_dwordx4 v[132:135], v6, s[8:11], s40 offen offset:256
    buffer_load_dwordx4 v[136:139], v7, s[8:11], s40 offen offset:0
    buffer_load_dwordx4 v[140:143], v7, s[8:11], s40 offen offset:256
    buffer_load_dwordx4 v[144:147], v8, s[8:11], s40 offen offset:0
    buffer_load_dwordx4 v[148:151], v8, s[8:11], s40 offen offset:256
    buffer_load_dwordx4 v[152:155], v9, s[8:11], s40 offen offset:0
    buffer_load_dwordx4 v[156:159], v9, s[8:11], s40 offen offset:256
    s_waitcnt vmcnt(8)
    v_mfma_f32_16x16x32_bf16 v[192:195], v[96:99], v[32:35], 0
    v_mfma_f32_16x16x32_bf16 v[196:199], v[112:115], v[32:35], 0
    v_mfma_f32_16x16x32_bf16 v[192:195], v[100:103], v[36:39], v[192:195]
    v_mfma_f32_16x16x32_bf16 v[196:199], v[116:119], v[36:39], v[196:199]
    v_mfma_f32_16x16x32_bf16 v[192:195], v[104:107], v[40:43], v[192:195]
    v_mfma_f32_16x16x32_bf16 v[196:199], v[120:123], v[40:43], v[196:199]
    v_mfma_f32_16x16x32_bf16 v[192:195], v[108:111], v[44:47], v[192:195]
    v_mfma_f32_16x16x32_bf16 v[196:199], v[124:127], v[44:47], v[196:199]
    s_nop 7
    v_mov_b32_dpp v235, v192 quad_perm:[0,0,2,2] row_mask:0xf bank_mask:0xf
    v_add_f32_dpp v224, v193, v235 quad_perm:[1,1,3,3] row_mask:0xf bank_mask:0xf
    v_mov_b32_dpp v235, v194 quad_perm:[0,0,2,2] row_mask:0xf bank_mask:0xf
    v_add_f32_dpp v225, v195, v235 quad_perm:[1,1,3,3] row_mask:0xf bank_mask:0xf
    v_mov_b32_dpp v235, v196 quad_perm:[0,0,2,2] row_mask:0xf bank_mask:0xf
    v_add_f32_dpp v226, v197, v235 quad_perm:[1,1,3,3] row_mask:0xf bank_mask:0xf
    v_mov_b32_dpp v235, v198 quad_perm:[0,0,2,2] row_mask:0xf bank_mask:0xf
    v_add_f32_dpp v227, v199, v235 quad_perm:[1,1,3,3] row_mask:0xf bank_mask:0xf
    v_cndmask_b32 v224, v244, v224, s[50:51]
    v_cndmask_b32 v225, v244, v225, s[52:53]
    v_cndmask_b32 v226, v244, v226, s[54:55]
    v_cndmask_b32 v227, v244, v227, s[56:57]
    v_max3_f32 v232, v224, v225, v226
    v_max3_f32 v232, v232, v227, v237
    v_mov_b32 v234, v232
    s_nop 1
    v_permlane16_swap_b32 v232, v234
    v_max_f32 v232, v232, v234
    v_mov_b32 v234, v232
    s_nop 1
    v_permlane32_swap_b32 v232, v234
    v_max_f32 v232, v232, v234
    v_mul_f32 v235, s49, v232
    v_mul_f32 v238, s49, v237
    v_sub_f32 v238, v238, v235
    v_exp_f32 v238, v238
    v_mov_b32 v237, v232
    v_fma_f32 v224, v224, s49, -v235
    v_fma_f32 v225, v225, s49, -v235
    v_fma_f32 v226, v226, s49, -v235
    v_fma_f32 v227, v227, s49, -v235
    v_exp_f32 v224, v224
    v_exp_f32 v225, v225
    v_exp_f32 v226, v226
    v_exp_f32 v227, v227
    v_mul_f32 v233, v233, v238
    v_add_f32 v233, v233, v224
    v_add_f32 v233, v233, v225
    v_add_f32 v233, v233, v226
    v_add_f32 v233, v233, v227
    v_mul_f32 v208, v208, v238
    v_mul_f32 v209, v209, v238
    v_mul_f32 v210, v210, v238
    v_mul_f32 v211, v211, v238
    v_mul_f32 v212, v212, v238
    v_mul_f32 v213, v213, v238
    v_mul_f32 v214, v214, v238
    v_mul_f32 v215, v215, v238
    v_cvt_pk_bf16_f32 v224, v224, v224
    v_cvt_pk_bf16_f32 v225, v225, v225
    v_cvt_pk_bf16_f32 v226, v226, v226
    v_cvt_pk_bf16_f32 v227, v227, v227
    v_and_b32 v64, v224, v20
    v_and_b32 v65, v224, v21
    v_and_b32 v66, v224, v22
    v_and_b32 v67, v224, v23
    v_and_b32 v68, v225, v20
    v_and_b32 v69, v225, v21
    v_and_b32 v70, v225, v22
    v_and_b32 v71, v225, v23
    v_and_b32 v72, v226, v20
    v_and_b32 v73, v226, v21
    v_and_b32 v74, v226, v22
    v_and_b32 v75, v226, v23
    v_and_b32 v76, v227, v20
    v_and_b32 v77, v227, v21
    v_and_b32 v78, v227, v22
    v_and_b32 v79, v227, v23
    s_waitcnt vmcnt(0)
    s_nop 0
    v_mfma_f32_16x16x32_bf16 v[208:211], v[128:131], v[64:67], v[208:211]
    v_mfma_f32_16x16x32_bf16 v[212:215], v[132:135], v[64:67], v[212:215]
    v_mfma_f32_16x16x32_bf16 v[208:211], v[136:139], v[68:71], v[208:211]
    v_mfma_f32_16x16x32_bf16 v[212:215], v[140:143], v[68:71], v[212:215]
    v_mfma_f32_16x16x32_bf16 v[208:211], v[144:147], v[72:75], v[208:211]
    v_mfma_f32_16x16x32_bf16 v[212:215], v[148:151], v[72:75], v[212:215]
    v_mfma_f32_16x16x32_bf16 v[208:211], v[152:155], v[76:79], v[208:211]
    v_mfma_f32_16x16x32_bf16 v[212:215], v[156:159], v[76:79], v[212:215]
    s_add_u32 s92, s92, 8
    s_branch L_gloop
L_gdone:
    v_mov_b32 v234, v233
    s_nop 1
    v_permlane16_swap_b32 v233, v234
    v_add_f32 v233, v233, v234
    v_mov_b32 v234, v233
    s_nop 1
    v_permlane32_swap_b32 v233, v234
    v_add_f32 v233, v233, v234
    v_mul_f32 v232, s49, v237
    v_lshlrev_b32 v24, 6, v2
    s_lshl_b32 s58, s3, 3
    s_add_u32 s58, s58, 133120
    v_add_u32 v24, s58, v24
    ds_write_b64 v24, v[232:233]
    s_lshl_b32 s58, s3, 2
    s_add_u32 s58, s58, 134144
    v_mov_b32 v25, s58
    v_mov_b32 v26, s72
    ds_write_b32 v25, v26
    s_waitcnt lgkmcnt(0)
    s_barrier
    s_branch L_pw
.p2align 7
.type plan_table,@object
plan_table:
.long 0x1c000020, 0xf801ff01
.long 0x18017120, 0xf871ff02
.long 0x1802d220, 0xf8f1ff03
.long 0x18043320, 0xf971ff04
.long 0x34059f20, 0xfa01ff05
.long 0x34076f20, 0xfa91ff06
.long 0x34093f20, 0xfb21ff07
.long 0x340b0f20, 0xfb91ff00
.long 0x1c0cd020, 0xf811ff11
.long 0x180e4120, 0xf881ff12
.long 0x180fa220, 0xf901ff13
.long 0x18110320, 0xf981ff14
.long 0x34126f20, 0xfa11ff15
.long 0x34143f20, 0xfaa1ff16
.long 0x34160f20, 0xfb31ff17
.long 0x3417df20, 0xfba1ff10
.long 0x1819a020, 0xf821ff21
.long 0x181b0120, 0xf891ff22
.long 0x181c6220, 0xf911ff23
.long 0x181dc320, 0xf991ff24
.long 0x341f2f20, 0xfa21ff25
.long 0x3420ff20, 0xfab1ff26
.long 0x3422cf20, 0xfb41ff27
.long 0x34249f20, 0xfbb1ff20
.long 0x1c266020, 0xf831ff31
.long 0x1827d120, 0xf8a1ff32
.long 0x18293220, 0xf921ff33
.long 0x182a9320, 0xf9a1ff34
.long 0x342bff20, 0xfa31ff35
.long 0x342dcf20, 0xfac1ff36
.long 0x342f9f20, 0xfb51ff37
.long 0x34316f20, 0xfbc1ff30
.long 0x1c333020, 0xf841ff41
.long 0x1834a120, 0xf8b1ff42
.long 0x18360220, 0xf931ff43
.long 0x18376320, 0xf9b1ff44
.long 0x3438cf20, 0xfa41ff45
.long 0x343a9f20, 0xfad1ff46
.long 0x343c6f20, 0xfb61ff47
.long 0x343e3f20, 0xfbd1ff40
.long 0x26000717, 0xfb91ff70
.long 0x22019f17, 0xfb91ff70
.long 0x22031f17, 0xfb91ff70
.long 0x22049f17, 0xfb91ff70
.long 0x36061f17, 0xfb91ff70
.long 0x3607ef17, 0xfb91ff70
.long 0x3609bf17, 0xfb91ff70
.long 0x360b8f17, 0xfb91ff70
.long 0x220d5707, 0xfb90ff00
.long 0x1e0edf07, 0xfb90ff00
.long 0x1e104f07, 0xfb90ff00
.long 0x1e11bf07, 0x390ff00
.long 0x36132f07, 0xfb90ff00
.long 0x3614ff07, 0xfb90ff00
.long 0x3616cf07, 0xfb90ff00
.long 0x36189f07, 0xfbe1ff50
.long 0x221a6707, 0xfb90ff00
.long 0x221bef07, 0xfb90ff00
.long 0x1e1d6f07, 0xfb90ff00
.long 0x1e1edf07, 0xb90ff00
.long 0x36204f07, 0xfb90ff00
.long 0x36221f07, 0xfb90ff00
.long 0x3623ef07, 0xfb90ff00
.long 0x3625bf07, 0xfbf1ff60
.long 0x2c400010, 0xf801ff71
.long 0x2c41bf10, 0xf801ff71
.long 0x28436f10, 0xf801ff71
.long 0x28450f10, 0xf801ff71
.long 0x3446af10, 0xf801ff71
.long 0x34487f10, 0xf801ff71
.long 0x344a4f10, 0xf801ff71
.long 0x344c1f10, 0xf801ff71
.long 0x284de000, 0xf800ff01
.long 0x284f8f00, 0xf800ff01
.long 0x28512f00, 0xf800ff01
.long 0x2852cf00, 0x1000ff01
.long 0x34546f00, 0xf800ff01
.long 0x34563f00, 0xf800ff01
.long 0x34580f00, 0xf800ff01
.long 0x3459df00, 0xf851ff51
.long 0x3c5ba000, 0xf8613d61
.long 0x10df303, 0xf970ff04
.long 0x385d9f00, 0xf800ff01
.long 0x385f7f00, 0x1800ff01
.long 0x34615f00, 0xf800ff01
.long 0x34632f00, 0xf800ff01
.long 0x2d0eff03, 0xf970ff04
.long 0x2d10af03, 0xf9c1c254
.long 0x2c800111, 0xf871ff82
.long 0x2c81bf11, 0xf871ff82
.long 0x2c836f11, 0xf871ff82
.long 0x28851f11, 0xf871ff82
.long 0x3486bf11, 0xf871ff82
.long 0x34888f11, 0xf871ff82
.long 0x348a5f11, 0xf871ff82
.long 0x348c2f11, 0xf871ff82
.long 0x1d2dc303, 0xf9f11d84
.long 0x3c8df101, 0xf870ff02
.long 0x192f3f03, 0xf970ff04
.long 0x19309f03, 0x2170ff04
.long 0x3531ff03, 0xf970ff04
.long 0x3c8fef01, 0xf870ff02
.long 0x3c91df01, 0xf870ff02
.long 0x3c93cf01, 0xf8c1e252
.long 0x2895b101, 0xf870ff02
.long 0x28975f01, 0xf870ff02
.long 0x2898ff01, 0xf870ff02
.long 0x249a9f01, 0x2870ff02
.long 0x349c2f01, 0xf870ff02
.long 0x349dff01, 0xf870ff02
.long 0x349fcf01, 0xf870ff02
.long 0x34a19f01, 0xf8d1ff62
.long 0x24a36101, 0xf8e11d72
.long 0x31cdc606, 0xfb20ff07
.long 0x24a4ff01, 0xf870ff02
.long 0x24a68f01, 0x3070ff02
.long 0x34a81f01, 0xf870ff02
.long 0x35cf8f06, 0xfb20ff07
.long 0x35d15f06, 0xfb20ff07
.long 0x35d32f06, 0xfb71e257
.long 0x2cc00212, 0xf8f1ff83
.long 0x2cc1bf12, 0xf8f1ff83
.long 0x2cc36f12, 0xf8f1ff83
.long 0x28c51f12, 0xf8f1ff83
.long 0x34c6bf12, 0xf8f1ff83
.long 0x34c88f12, 0xf8f1ff83
.long 0x34ca5f12, 0xf8f1ff83
.long 0x34cc2f12, 0xf8f1ff83
.long 0x28cdf202, 0xf8f0ff03
.long 0x28cf9f02, 0xf8f0ff03
.long 0x28d13f02, 0xf8f0ff03
.long 0x28d2df02, 0x38f0ff03
.long 0x34d47f02, 0xf8f0ff03
.long 0x34d64f02, 0xf8f0ff03
.long 0x34d81f02, 0xf8f0ff03
.long 0x34d9ef02, 0xf941ff53
.long 0x28dbb202, 0xf8f0ff03
.long 0x28dd5f02, 0xf8f0ff03
.long 0x28deff02, 0xf8f0ff03
.long 0x28e09f02, 0x40f0ff03
.long 0x34e23f02, 0xf8f0ff03
.long 0x34e40f02, 0xf8f0ff03
.long 0x34e5df02, 0xf8f0ff03
.long 0x34e7af02, 0xf951ff63
.long 0x34e97202, 0xf9610d73
.long 0x94df404, 0xfa00ff05
.long 0x34eb4f02, 0xf8f0ff03
.long 0x30ed1f02, 0x48f0ff03
.long 0x354f1f04, 0xfa00ff05
.long 0x3550ef04, 0xfa00ff05
.long 0x3552bf04, 0xfa00ff05
.long 0x35548f04, 0xfa51f255
.long 0x2d000313, 0xf971ff94
.long 0x2d01bf13, 0xf971ff94
.long 0x2d036f13, 0xf971ff94
.long 0x29051f13, 0xf971ff94
.long 0x3506bf13, 0xf971ff94
.long 0x35088f13, 0xf971ff94
.long 0x350a5f13, 0xf971ff94
.long 0x350c2f13, 0xf971ff94
.long 0x29125303, 0xf970ff04
.long 0x2913ff03, 0xf970ff04
.long 0x29159f03, 0xf970ff04
.long 0x25173f03, 0x5170ff04
.long 0x3518cf03, 0xf970ff04
.long 0x351a9f03, 0xf970ff04
.long 0x351c6f03, 0xf970ff04
.long 0x351e3f03, 0xf9d1ff64
.long 0x29200303, 0xf970ff04
.long 0x2921af03, 0xf970ff04
.long 0x29234f03, 0xf970ff04
.long 0x2924ef03, 0x5970ff04
.long 0x35268f03, 0xf970ff04
.long 0x35285f03, 0xf970ff04
.long 0x352a2f03, 0xf970ff04
.long 0x352bff03, 0xf9e1ff74
.long 0x2d400414, 0xfa01ff95
.long 0x2d41bf14, 0xfa01ff95
.long 0x2d436f14, 0xfa01ff95
.long 0x29451f14, 0xfa01ff95
.long 0x3546bf14, 0xfa01ff95
.long 0x35488f14, 0xfa01ff95
.long 0x354a5f14, 0xfa01ff95
.long 0x354c2f14, 0xfa01ff95
.long 0x29565404, 0xfa00ff05
.long 0x2957ff04, 0xfa00ff05
.long 0x29599f04, 0xfa00ff05
.long 0x255b3f04, 0x6200ff05
.long 0x355ccf04, 0xfa00ff05
.long 0x355e9f04, 0xfa00ff05
.long 0x35606f04, 0xfa00ff05
.long 0x35623f04, 0xfa61ff65
.long 0x29640404, 0xfa00ff05
.long 0x2965af04, 0xfa00ff05
.long 0x29674f04, 0xfa00ff05
.long 0x2968ef04, 0x6a00ff05
.long 0x356a8f04, 0xfa00ff05
.long 0x356c5f04, 0xfa00ff05
.long 0x356e2f04, 0xfa00ff05
.long 0x356fff04, 0xfa71ff75
.long 0x3171c404, 0xfa811d85
.long 0x198de505, 0xfa90ff06
.long 0x2d738f04, 0xfa00ff05
.long 0x2d753f04, 0x7200ff05
.long 0x3576ef04, 0xfa00ff05
.long 0x358f4f05, 0xfa90ff06
.long 0x35911f05, 0xfa90ff06
.long 0x3592ef05, 0xfae1e256
.long 0x2d800515, 0xfa91ff96
.long 0x2d81bf15, 0xfa91ff96
.long 0x29836f15, 0xfa91ff96
.long 0x29850f15, 0xfa91ff96
.long 0x3586af15, 0xfa91ff96
.long 0x35887f15, 0xfa91ff96
.long 0x358a4f15, 0xfa91ff96
.long 0x358c1f15, 0xfa91ff96
.long 0x2994b505, 0xfa90ff06
.long 0x29965f05, 0xfa90ff06
.long 0x2997ff05, 0xfa90ff06
.long 0x25999f05, 0x7a90ff06
.long 0x359b2f05, 0xfa90ff06
.long 0x359cff05, 0xfa90ff06
.long 0x359ecf05, 0xfa90ff06
.long 0x35a09f05, 0xfaf1ff66
.long 0x29a26505, 0xfa90ff06
.long 0x29a40f05, 0xfa90ff06
.long 0x25a5af05, 0xfa90ff06
.long 0x25a73f05, 0x8290ff06
.long 0x35a8cf05, 0xfa90ff06
.long 0x35aa9f05, 0xfa90ff06
.long 0x35ac6f05, 0xfa90ff06
.long 0x35ae3f05, 0xfb01ff76
.long 0x29b00505, 0xfa90ff06
.long 0x29b1af05, 0xfa90ff06
.long 0x25b34f05, 0xfa90ff06
.long 0x25b4df05, 0x8a90ff06
.long 0x35b66f05, 0xfa90ff06
.long 0x35b83f05, 0xfa90ff06
.long 0x35ba0f05, 0xfa90ff06
.long 0x35bbdf05, 0xfb11ff86
.long 0x29c00616, 0xfb21ff77
.long 0x29c1af16, 0xfb21ff77
.long 0x29c34f16, 0xfb21ff77
.long 0x29c4ef16, 0xfb21ff77
.long 0x35c68f16, 0xfb21ff77
.long 0x35c85f16, 0xfb21ff77
.long 0x35ca2f16, 0xfb21ff77
.long 0x35cbff16, 0xfb21ff77
.long 0x29d4f606, 0xfb20ff07
.long 0x29d69f06, 0xfb20ff07
.long 0x25d83f06, 0xfb20ff07
.long 0x25d9cf06, 0x9320ff07
.long 0x35db5f06, 0xfb20ff07
.long 0x35dd2f06, 0xfb20ff07
.long 0x35deff06, 0xfb20ff07
.long 0x35e0cf06, 0xfb81ff67
.size plan_table, 2048
.section .rodata,"a"
.p2align 6
.amdhsa_kernel standalone__paged_block_table_kv_radixattention__sampling_kernel
.amdhsa_next_free_vgpr 256
.amdhsa_next_free_sgpr 102
.amdhsa_accum_offset 256
.amdhsa_group_segment_fixed_size 0
.amdhsa_kernarg_size 64
.amdhsa_user_sgpr_count 2
.amdhsa_user_sgpr_kernarg_segment_ptr 1
.amdhsa_system_sgpr_workgroup_id_x 1
.amdhsa_float_denorm_mode_32 3
.end_amdhsa_kernel
```
